```python
import torch

def _softmax(x, axis=-1):
    return torch.softmax(x, dim=axis)
def _gelu(x):
    return torch.nn.functional.gelu(x, approximate="tanh")
def _silu(x):
    return torch.nn.functional.silu(x)
def _sigmoid(x):
    return torch.sigmoid(x)
def _layernorm(x, axis=-1, eps=1e-5):
    m = x.mean(dim=axis, keepdim=True)
    v = x.var(dim=axis, keepdim=True, unbiased=False)
    return (x - m) / torch.sqrt(v + eps)
def _scatter_add(tgt, idx, src, axis=0):
    return tgt.clone().index_add_(axis, idx, src)
def _segment_sum(src, seg, n):
    out = torch.zeros((n,) + src.shape[1:], dtype=src.dtype)
    return out.index_add_(0, seg, src)
def _pad(x, pw):
    flat = tuple(v for pair in reversed(pw) for v in pair)
    return torch.nn.functional.pad(x, flat)

kernel_name = 'standalone__gqa_block_cached__near_ridge'

def setup_inputs():

    _w = (lambda a: (lambda t: t.to(torch.bfloat16) if t.is_floating_point() else t)(torch.as_tensor(a)))
    B, Sq, D = 8, 64, 512
    Hq, Hkv, Sk, Dh = 32, 8, 1024, 128
    assert Hq % Hkv == 0, (Hq, Hkv)
    return {
        "x": _w((lambda *s: torch.randn(*s, dtype=torch.bfloat16) * 0.8)(B, Sq, D)),
        "k_cache": _w((lambda *s: torch.randn(*s, dtype=torch.bfloat16) * 0.8)(B, Hkv, Sk, Dh)),
        "v_cache": _w((lambda *s: torch.randn(*s, dtype=torch.bfloat16) * 0.05)(B, Hkv, Sk, Dh)),
        "wq": _w((lambda *s: torch.randn(*s, dtype=torch.bfloat16) * 0.8)(D, Hq * Dh) * (D ** -0.5)),
        "wo": _w((lambda *s: torch.randn(*s, dtype=torch.bfloat16) * 0.05)(Hq * Dh, D) * ((Hq * Dh) ** -0.5)),
    }

def reference(x, k_cache, v_cache, wq, wo):
    B, Sq, D = x.shape
    Hq, Dh = 32, 128
    Hkv = k_cache.shape[1]
    rep = Hq // Hkv
    q = (lambda x, *d: x.permute(*d))((x @ wq).reshape(B, Sq, Hq, Dh), 0, 2, 1, 3)
    k = (lambda x, n, axis: torch.repeat_interleave(x, n, dim=axis))(k_cache, rep, axis=1)
    v = (lambda x, n, axis: torch.repeat_interleave(x, n, dim=axis))(v_cache, rep, axis=1)
    scores = torch.einsum("bhqd,bhkd->bhqk", q, k) * (Dh ** -0.5)
    p = _softmax(scores, axis=-1)
    o = torch.einsum("bhqk,bhkd->bhqd", p, v)
    return (lambda x, *d: x.permute(*d))(o, 0, 2, 1, 3).reshape(B, Sq, Hq * Dh) @ wo
```

```asm
; @launch grid=(256,1,1) block=(256,1,1) lds=163840
.amdgcn_target "amdgcn-amd-amdhsa--gfx950"
.text
.globl standalone__gqa_block_cached__near_ridge_kernel
.p2align 8
.type standalone__gqa_block_cached__near_ridge_kernel,@function
standalone__gqa_block_cached__near_ridge_kernel:
    s_load_dwordx2 s[16:17], s[0:1], 24
    s_load_dwordx2 s[4:5], s[0:1], 0
    s_cmp_ge_u32 s2, 256
    s_cbranch_scc1 K_end
    s_getpc_b64 s[98:99]
K_pc:
    s_and_b32 s100, s2, 0xf8
    v_lshrrev_b32 v49, 5, v0
    v_add_lshl_u32 v49, v49, s100, 7
    v_min_u32 v49, K_hot_end-K_pc, v49
    global_load_dword v62, v49, s[98:99]
    v_lshrrev_b32 v4, 6, v0
    v_and_b32 v1, 63, v0
    v_readfirstlane_b32 s36, v4
    v_lshrrev_b32 v2, 4, v1
    v_and_b32 v3, 15, v1
    s_and_b32 s37, s2, 7
    s_lshr_b32 s39, s2, 5
    s_bfe_u32 s38, s2, 0x20003
    s_lshl2_add_u32 s43, s37, s38
    v_lshlrev_b32 v48, 2, v2
    v_xor_b32 v48, v48, v3
    v_lshlrev_b32 v48, 4, v48
    v_lshl_add_u32 v37, v2, 13, v48
    v_add_u32 v5, 130048, v37
    v_add_u32 v6, 260096, v37
    v_add_u32 v7, 390144, v37
    v_lshrrev_b32 v49, 4, v0
    v_xor_b32 v49, v49, v1
    v_and_b32 v49, 7, v49
    v_lshlrev_b32 v49, 4, v49
    v_lshrrev_b32 v50, 3, v0
    v_lshl_add_u32 v38, v50, 10, v49
    v_add_u32 v254, 31744, v38
    s_mul_i32 s40, s36, 40960
    s_lshl1_add_u32 s45, s38, s39
    s_and_b32 s45, s45, 6
    s_lshl4_add_u32 s41, s45, s36
    s_lshl_b32 s41, s41, 7
    s_add_u32 s41, s41, s43
    s_lshl_b32 s41, s41, 8
    s_lshl_b32 s96, s39, 9
    s_add_u32 s45, s45, s96
    s_lshl_b32 s45, s45, 7
    s_mov_b32 s19, 0x20000
    s_lshl_b32 s18, s19, 5
    s_lshl_b32 s6, s19, 2
    s_mov_b32 s7, s19
    s_waitcnt lgkmcnt(0)
    s_add_u32 m0, s40, 32768
    s_nop 0
    buffer_load_dwordx4 v37, s[16:19], s41 offen offset:0 lds
    buffer_load_dwordx4 v5, s[16:19], s41 offen offset:1024 lds
    buffer_load_dwordx4 v6, s[16:19], s41 offen offset:2048 lds
    buffer_load_dwordx4 v7, s[16:19], s41 offen offset:3072 lds
    s_add_u32 m0, s40, 36864
    s_nop 0
    buffer_load_dwordx4 v38, s[4:7], s45 offen lds
    buffer_load_dwordx4 v254, s[4:7], s45 offen offset:1024 lds
    s_add_u32 m0, s40, 0
    s_add_u32 s41, s41, 0x80000
    s_and_b32 s41, s41, 0x3fffff
    buffer_load_dwordx4 v37, s[16:19], s41 offen offset:0 lds
    buffer_load_dwordx4 v5, s[16:19], s41 offen offset:1024 lds
    s_load_dwordx2 s[8:9], s[0:1], 8
    s_load_dwordx2 s[12:13], s[0:1], 16
    s_load_dwordx2 s[20:21], s[0:1], 56
    s_load_dwordx2 s[24:25], s[0:1], 32
    s_load_dwordx2 s[28:29], s[0:1], 40
    s_load_dwordx2 s[32:33], s[0:1], 48
    s_memrealtime s[46:47]
    s_mov_b32 s10, 0x1000000
    s_mov_b32 s11, s19
    s_mov_b32 s14, s10
    s_mov_b32 s15, s19
    s_mov_b32 s22, 0x10000000
    s_mov_b32 s23, s19
    s_mov_b32 s26, s18
    s_mov_b32 s27, s19
    s_mov_b32 s30, s6
    s_mov_b32 s31, s19
    s_movk_i32 s34, 0x100
    s_mov_b32 s35, s19
    v_mov_b32 v239, 0
    v_lshl_add_u32 v36, v2, 8, v48
    v_lshrrev_b32 v48, 2, v3
    v_xor_b32 v49, s36, v48
    v_lshlrev_b32 v49, 6, v49
    v_lshl_add_u32 v49, v48, 8, v49
    v_and_b32 v50, 1, v2
    v_lshl_add_u32 v49, v50, 5, v49
    v_and_b32 v50, 1, v1
    v_lshl_add_u32 v49, v50, 4, v49
    v_and_b32 v50, 2, v1
    v_lshl_add_u32 v49, v50, 2, v49
    v_lshrrev_b32 v51, 5, v1
    v_mul_u32_u24 v50, 81920, v51
    v_add_u32 v39, v49, v50
    v_add_u32 v40, 40960, v39
    v_and_b32 v52, 31, v1
    v_lshrrev_b32 v54, 3, v52
    v_mul_u32_u24 v48, 40960, v54
    v_and_b32 v55, 7, v1
    v_lshl_add_u32 v48, v55, 7, v48
    v_bfe_u32 v49, v1, 1, 3
    v_xor_b32 v49, v49, v51
    v_xor_b32 v50, 0, v49
    v_lshl_add_u32 v41, v50, 4, v48
    v_xor_b32 v50, 2, v49
    v_lshl_add_u32 v42, v50, 4, v48
    v_xor_b32 v50, 4, v49
    v_lshl_add_u32 v43, v50, 4, v48
    v_xor_b32 v50, 6, v49
    v_lshl_add_u32 v44, v50, 4, v48
    s_lshl3_add_u32 s98, s39, s37
    s_lshl_b32 s98, s98, 18
    s_lshl_b32 s99, s37, 19
    s_lshl_b32 s100, s39, 21
    s_add_u32 s100, s100, 0x1f0000
    v_or_b32 v60, s2, v0
    v_lshlrev_b32 v60, 8, v60
    s_waitcnt lgkmcnt(0)
    s_or_b32 s46, s46, 1
    v_mov_b32 v58, s46
    v_mov_b32 v59, s47
    buffer_store_dwordx2 v[58:59], v60, s[32:35], 0 offen sc1
    buffer_load_dword v62, v239, s[8:11], s98 offen
    buffer_load_dword v62, v239, s[12:15], s98 offen
    buffer_load_dword v62, v239, s[24:27], s99 offen
    buffer_load_dword v62, v239, s[20:23], s100 offen
    v_lshlrev_b32 v48, 8, v52
    v_add_u32 v48, s40, v48
    v_xor_b32 v49, v3, v51
    v_xor_b32 v50, 0, v49
    v_lshl_add_u32 v8, v50, 4, v48
    v_xor_b32 v50, 2, v49
    v_lshl_add_u32 v9, v50, 4, v48
    v_xor_b32 v50, 4, v49
    v_lshl_add_u32 v10, v50, 4, v48
    v_xor_b32 v50, 6, v49
    v_lshl_add_u32 v11, v50, 4, v48
    v_xor_b32 v50, 8, v49
    v_lshl_add_u32 v12, v50, 4, v48
    v_xor_b32 v50, 10, v49
    v_lshl_add_u32 v13, v50, 4, v48
    v_xor_b32 v50, 12, v49
    v_lshl_add_u32 v14, v50, 4, v48
    v_xor_b32 v50, 14, v49
    v_lshl_add_u32 v15, v50, 4, v48
    v_lshrrev_b32 v49, 2, v3
    v_lshl_add_u32 v48, v51, 2, v49
    v_and_b32 v50, 1, v2
    v_lshlrev_b32 v53, 5, v50
    v_lshl_add_u32 v238, v55, 10, v53
    v_lshl_add_u32 v238, v51, 4, v238
    v_and_b32 v50, 8, v1
    v_add_u32 v238, v238, v50
    v_and_b32 v50, 3, v1
    v_lshl_add_u32 v53, v50, 3, v53
    v_add_u32 v53, s40, v53
    v_lshl_add_u32 v253, v48, 6, v53
    v_lshl_add_u32 v48, v48, 8, v53
    s_and_b32 s98, s36, 2
    v_xor_b32 v49, s98, v49
    v_xor_b32 v50, 0, v49
    v_lshl_add_u32 v24, v50, 6, v48
    v_xor_b32 v50, 1, v49
    v_lshl_add_u32 v25, v50, 6, v48
    v_xor_b32 v50, 2, v49
    v_lshl_add_u32 v26, v50, 6, v48
    v_xor_b32 v50, 3, v49
    v_lshl_add_u32 v27, v50, 6, v48
    s_xor_b32 s98, s36, 1
    s_mul_i32 s98, s98, 40960
    s_sub_u32 s98, s98, s40
    v_add_u32 v16, s98, v8
    v_add_u32 v17, s98, v9
    v_add_u32 v18, s98, v10
    v_add_u32 v19, s98, v11
    v_add_u32 v20, s98, v12
    v_add_u32 v21, s98, v13
    v_add_u32 v22, s98, v14
    v_add_u32 v23, s98, v15
    v_add_u32 v28, s98, v24
    v_add_u32 v29, s98, v25
    v_add_u32 v30, s98, v26
    v_add_u32 v31, s98, v27
    v_xor_b32 v49, v3, v2
    v_lshlrev_b32 v48, 8, v2
    v_xor_b32 v50, 0, v49
    v_lshl_add_u32 v32, v50, 4, v48
    v_xor_b32 v50, 4, v49
    v_lshl_add_u32 v33, v50, 4, v48
    v_xor_b32 v50, 8, v49
    v_lshl_add_u32 v34, v50, 4, v48
    v_xor_b32 v50, 12, v49
    v_lshl_add_u32 v35, v50, 4, v48
    v_lshlrev_b32 v47, 4, v1
    v_add_u32 v247, s40, v47
    s_xor_b32 s98, s36, 2
    s_mul_i32 s98, s98, 40960
    v_add_u32 v248, s98, v47
    v_lshrrev_b32 v48, 2, v1
    v_and_b32 v49, 3, v1
    v_lshlrev_b32 v48, 10, v48
    v_lshl_add_u32 v249, v49, 4, v48
    v_add_u32 v250, 15360, v249
    v_add_u32 v251, 30720, v249
    v_add_u32 v252, 46080, v249
    v_lshlrev_b32 v245, 6, v1
    v_lshrrev_b32 v48, 3, v1
    v_lshlrev_b32 v48, 14, v48
    v_lshl_add_u32 v246, v55, 6, v48
    v_lshlrev_b32 v244, 6, v55
    v_cmp_gt_u32 vcc, 8, v1
    v_mov_b32 v50, 0x20000
    s_nop 0
    v_cndmask_b32 v244, v50, v244, vcc
    v_lshl_add_u32 v48, v51, 3, v55
    v_lshlrev_b32 v50, 14, v54
    v_lshl_add_u32 v235, v48, 4, v50
    v_lshl_add_u32 v48, v54, 4, v48
    v_lshlrev_b32 v236, 2, v48
    v_lshlrev_b32 v48, 2, v3
    v_lshl_add_u32 v237, v51, 9, v48
    v_max_u32 v48, 1, v49
    v_lshlrev_b32 v48, 3, v48
    s_and_b32 s98, s2, 31
    v_xor_b32 v48, s98, v48
    v_lshlrev_b32 v63, 9, v48
    v_and_b32 v48, 1, v1
    v_lshlrev_b32 v48, 4, v48
    v_mov_b32 v49, 0x3f80
    v_lshlrev_b32 v48, v48, v49
    v_lshrrev_b32 v49, 1, v52
    v_cmp_eq_u32 vcc, 0, v49
    s_nop 1
    v_cndmask_b32 v240, 0, v48, vcc
    v_cmp_eq_u32 vcc, 1, v49
    s_nop 1
    v_cndmask_b32 v241, 0, v48, vcc
    v_cmp_eq_u32 vcc, 2, v49
    s_nop 1
    v_cndmask_b32 v242, 0, v48, vcc
    v_cmp_eq_u32 vcc, 3, v49
    s_nop 1
    v_cndmask_b32 v243, 0, v48, vcc
    s_lshl_b32 s98, s39, 3
    s_add_u32 s98, s98, s37
    s_lshl_b32 s98, s98, 2
    s_add_u32 s98, s98, s36
    s_lshl_b32 s98, s98, 16
    s_and_b32 s99, s39, 0
    s_lshl_b32 s99, s99, 2
    s_add_u32 s99, s99, s38
    s_mov_b32 s100, 0x76453201
    s_cmp_eq_u32 s99, 1
    s_cselect_b32 s100, 0x75643120, s100
    s_cmp_eq_u32 s99, 2
    s_cselect_b32 s100, 0x67542310, s100
    s_cmp_eq_u32 s99, 3
    s_cselect_b32 s100, 0x76534210, s100
    s_bfe_u32 s48, s100, 0x30000
    s_lshl_b32 s48, s48, 13
    s_add_u32 s48, s48, s98
    s_add_u32 s49, s48, 4096
    s_bfe_u32 s50, s100, 0x30004
    s_lshl_b32 s50, s50, 13
    s_add_u32 s50, s50, s98
    s_add_u32 s51, s50, 4096
    s_bfe_u32 s52, s100, 0x30008
    s_lshl_b32 s52, s52, 13
    s_add_u32 s52, s52, s98
    s_add_u32 s53, s52, 4096
    s_bfe_u32 s54, s100, 0x3000c
    s_lshl_b32 s54, s54, 13
    s_add_u32 s54, s54, s98
    s_add_u32 s55, s54, 4096
    s_bfe_u32 s56, s100, 0x30010
    s_lshl_b32 s56, s56, 13
    s_add_u32 s56, s56, s98
    s_add_u32 s57, s56, 4096
    s_bfe_u32 s58, s100, 0x30014
    s_lshl_b32 s58, s58, 13
    s_add_u32 s58, s58, s98
    s_add_u32 s59, s58, 4096
    s_bfe_u32 s60, s100, 0x30018
    s_lshl_b32 s60, s60, 13
    s_add_u32 s60, s60, s98
    s_add_u32 s61, s60, 4096
    s_bfe_u32 s62, s100, 0x3001c
    s_lshl_b32 s62, s62, 13
    s_add_u32 s62, s62, s98
    s_add_u32 s63, s62, 4096
    s_mov_b32 s44, 0x46800000
    s_mov_b32 s3, 0x3f803f80
    buffer_load_dwordx4 v6, s[16:19], s41 offen offset:2048 lds
    buffer_load_dwordx4 v7, s[16:19], s41 offen offset:3072 lds
    s_add_u32 m0, s40, 4096
    s_add_u32 s45, s45, 128
    s_and_b32 s45, s45, 0xfffffbff
    buffer_load_dwordx4 v38, s[4:7], s45 offen lds
    buffer_load_dwordx4 v254, s[4:7], s45 offen offset:1024 lds
    s_add_u32 m0, s40, 8192
    s_add_u32 s41, s41, 0x80000
    s_and_b32 s41, s41, 0x3fffff
    buffer_load_dwordx4 v37, s[16:19], s41 offen offset:0 lds
    buffer_load_dwordx4 v5, s[16:19], s41 offen offset:1024 lds
    buffer_load_dwordx4 v6, s[16:19], s41 offen offset:2048 lds
    buffer_load_dwordx4 v7, s[16:19], s41 offen offset:3072 lds
    s_add_u32 m0, s40, 12288
    s_add_u32 s45, s45, 128
    s_and_b32 s45, s45, 0xfffffbff
    buffer_load_dwordx4 v38, s[4:7], s45 offen lds
    buffer_load_dwordx4 v254, s[4:7], s45 offen offset:1024 lds
    s_waitcnt vmcnt(17)
    s_barrier
    ds_read_b64_tr_b16 a[64:65], v39 offset:32768
    ds_read_b64_tr_b16 a[66:67], v40 offset:32768
    ds_read_b128 a[0:3], v41 offset:36864
    ds_read_b128 a[4:7], v41 offset:37888
    ds_read_b64_tr_b16 a[68:69], v39 offset:33792
    ds_read_b64_tr_b16 a[70:71], v40 offset:33792
    ds_read_b128 a[8:11], v42 offset:36864
    ds_read_b128 a[12:15], v42 offset:37888
    ds_read_b64_tr_b16 a[72:73], v39 offset:34816
    ds_read_b64_tr_b16 a[74:75], v40 offset:34816
    ds_read_b128 a[16:19], v43 offset:36864
    ds_read_b128 a[20:23], v43 offset:37888
    ds_read_b64_tr_b16 a[76:77], v39 offset:35840
    ds_read_b64_tr_b16 a[78:79], v40 offset:35840
    ds_read_b128 a[24:27], v44 offset:36864
    ds_read_b128 a[28:31], v44 offset:37888
    s_waitcnt lgkmcnt(8)
    v_mfma_f32_32x32x16_bf16 v[64:79], a[64:67], a[0:3], 0
    s_add_u32 m0, s40, 16384
    s_add_u32 s41, s41, 0x80000
    s_and_b32 s41, s41, 0x3fffff
    v_mfma_f32_32x32x16_bf16 v[80:95], a[64:67], a[4:7], 0
    buffer_load_dwordx4 v37, s[16:19], s41 offen offset:0 lds
    buffer_load_dwordx4 v5, s[16:19], s41 offen offset:1024 lds
    buffer_load_dwordx4 v6, s[16:19], s41 offen offset:2048 lds
    v_mfma_f32_32x32x16_bf16 v[64:79], a[68:71], a[8:11], v[64:79]
    buffer_load_dwordx4 v7, s[16:19], s41 offen offset:3072 lds
    s_add_u32 m0, s40, 20480
    s_add_u32 s45, s45, 128
    v_mfma_f32_32x32x16_bf16 v[80:95], a[68:71], a[12:15], v[80:95]
    s_and_b32 s45, s45, 0xfffffbff
    buffer_load_dwordx4 v38, s[4:7], s45 offen lds
    buffer_load_dwordx4 v254, s[4:7], s45 offen offset:1024 lds
    s_waitcnt lgkmcnt(0)
    s_waitcnt vmcnt(12)
    s_barrier
    v_mfma_f32_32x32x16_bf16 v[64:79], a[72:75], a[16:19], v[64:79]
    ds_read_b64_tr_b16 a[80:81], v39 offset:0
    ds_read_b64_tr_b16 a[82:83], v40 offset:0
    ds_read_b128 a[32:35], v41 offset:4096
    ds_read_b128 a[36:39], v41 offset:5120
    v_mfma_f32_32x32x16_bf16 v[80:95], a[72:75], a[20:23], v[80:95]
    ds_read_b64_tr_b16 a[84:85], v39 offset:1024
    ds_read_b64_tr_b16 a[86:87], v40 offset:1024
    ds_read_b128 a[40:43], v42 offset:4096
    ds_read_b128 a[44:47], v42 offset:5120
    v_mfma_f32_32x32x16_bf16 v[64:79], a[76:79], a[24:27], v[64:79]
    ds_read_b64_tr_b16 a[88:89], v39 offset:2048
    ds_read_b64_tr_b16 a[90:91], v40 offset:2048
    ds_read_b128 a[48:51], v43 offset:4096
    ds_read_b128 a[52:55], v43 offset:5120
    v_mfma_f32_32x32x16_bf16 v[80:95], a[76:79], a[28:31], v[80:95]
    ds_read_b64_tr_b16 a[92:93], v39 offset:3072
    ds_read_b64_tr_b16 a[94:95], v40 offset:3072
    ds_read_b128 a[56:59], v44 offset:4096
    ds_read_b128 a[60:63], v44 offset:5120
    s_waitcnt lgkmcnt(8)
    v_mfma_f32_32x32x16_bf16 v[64:79], a[80:83], a[32:35], v[64:79]
    s_add_u32 m0, s40, 32768
    s_add_u32 s41, s41, 0x80000
    s_and_b32 s41, s41, 0x3fffff
    v_mfma_f32_32x32x16_bf16 v[80:95], a[80:83], a[36:39], v[80:95]
    buffer_load_dwordx4 v37, s[16:19], s41 offen offset:0 lds
    buffer_load_dwordx4 v5, s[16:19], s41 offen offset:1024 lds
    buffer_load_dwordx4 v6, s[16:19], s41 offen offset:2048 lds
    v_mfma_f32_32x32x16_bf16 v[64:79], a[84:87], a[40:43], v[64:79]
    buffer_load_dwordx4 v7, s[16:19], s41 offen offset:3072 lds
    s_add_u32 m0, s40, 36864
    s_add_u32 s45, s45, 128
    v_mfma_f32_32x32x16_bf16 v[80:95], a[84:87], a[44:47], v[80:95]
    s_and_b32 s45, s45, 0xfffffbff
    buffer_load_dwordx4 v38, s[4:7], s45 offen lds
    buffer_load_dwordx4 v254, s[4:7], s45 offen offset:1024 lds
    s_waitcnt lgkmcnt(0)
    s_waitcnt vmcnt(12)
    s_barrier
    v_mfma_f32_32x32x16_bf16 v[64:79], a[88:91], a[48:51], v[64:79]
    ds_read_b64_tr_b16 a[64:65], v39 offset:8192
    ds_read_b64_tr_b16 a[66:67], v40 offset:8192
    ds_read_b128 a[0:3], v41 offset:12288
    ds_read_b128 a[4:7], v41 offset:13312
    v_mfma_f32_32x32x16_bf16 v[80:95], a[88:91], a[52:55], v[80:95]
    ds_read_b64_tr_b16 a[68:69], v39 offset:9216
    ds_read_b64_tr_b16 a[70:71], v40 offset:9216
    ds_read_b128 a[8:11], v42 offset:12288
    ds_read_b128 a[12:15], v42 offset:13312
    v_mfma_f32_32x32x16_bf16 v[64:79], a[92:95], a[56:59], v[64:79]
    ds_read_b64_tr_b16 a[72:73], v39 offset:10240
    ds_read_b64_tr_b16 a[74:75], v40 offset:10240
    ds_read_b128 a[16:19], v43 offset:12288
    ds_read_b128 a[20:23], v43 offset:13312
    v_mfma_f32_32x32x16_bf16 v[80:95], a[92:95], a[60:63], v[80:95]
    ds_read_b64_tr_b16 a[76:77], v39 offset:11264
    ds_read_b64_tr_b16 a[78:79], v40 offset:11264
    ds_read_b128 a[24:27], v44 offset:12288
    ds_read_b128 a[28:31], v44 offset:13312
    s_waitcnt lgkmcnt(8)
    v_mfma_f32_32x32x16_bf16 v[64:79], a[64:67], a[0:3], v[64:79]
    s_add_u32 m0, s40, 0
    s_add_u32 s41, s41, 0x80000
    s_and_b32 s41, s41, 0x3fffff
    v_mfma_f32_32x32x16_bf16 v[80:95], a[64:67], a[4:7], v[80:95]
    buffer_load_dwordx4 v37, s[16:19], s41 offen offset:0 lds
    buffer_load_dwordx4 v5, s[16:19], s41 offen offset:1024 lds
    buffer_load_dwordx4 v6, s[16:19], s41 offen offset:2048 lds
    v_mfma_f32_32x32x16_bf16 v[64:79], a[68:71], a[8:11], v[64:79]
    buffer_load_dwordx4 v7, s[16:19], s41 offen offset:3072 lds
    s_add_u32 m0, s40, 4096
    s_add_u32 s45, s45, 128
    v_mfma_f32_32x32x16_bf16 v[80:95], a[68:71], a[12:15], v[80:95]
    s_and_b32 s45, s45, 0xfffffbff
    buffer_load_dwordx4 v38, s[4:7], s45 offen lds
    buffer_load_dwordx4 v254, s[4:7], s45 offen offset:1024 lds
    s_waitcnt lgkmcnt(0)
    s_waitcnt vmcnt(12)
    s_barrier
    v_mfma_f32_32x32x16_bf16 v[64:79], a[72:75], a[16:19], v[64:79]
    ds_read_b64_tr_b16 a[80:81], v39 offset:16384
    ds_read_b64_tr_b16 a[82:83], v40 offset:16384
    ds_read_b128 a[32:35], v41 offset:20480
    ds_read_b128 a[36:39], v41 offset:21504
    v_mfma_f32_32x32x16_bf16 v[80:95], a[72:75], a[20:23], v[80:95]
    ds_read_b64_tr_b16 a[84:85], v39 offset:17408
    ds_read_b64_tr_b16 a[86:87], v40 offset:17408
    ds_read_b128 a[40:43], v42 offset:20480
    ds_read_b128 a[44:47], v42 offset:21504
    v_mfma_f32_32x32x16_bf16 v[64:79], a[76:79], a[24:27], v[64:79]
    ds_read_b64_tr_b16 a[88:89], v39 offset:18432
    ds_read_b64_tr_b16 a[90:91], v40 offset:18432
    ds_read_b128 a[48:51], v43 offset:20480
    ds_read_b128 a[52:55], v43 offset:21504
    v_mfma_f32_32x32x16_bf16 v[80:95], a[76:79], a[28:31], v[80:95]
    ds_read_b64_tr_b16 a[92:93], v39 offset:19456
    ds_read_b64_tr_b16 a[94:95], v40 offset:19456
    ds_read_b128 a[56:59], v44 offset:20480
    ds_read_b128 a[60:63], v44 offset:21504
    s_waitcnt lgkmcnt(8)
    v_mfma_f32_32x32x16_bf16 v[64:79], a[80:83], a[32:35], v[64:79]
    s_add_u32 m0, s40, 8192
    s_add_u32 s41, s41, 0x80000
    s_and_b32 s41, s41, 0x3fffff
    v_mfma_f32_32x32x16_bf16 v[80:95], a[80:83], a[36:39], v[80:95]
    buffer_load_dwordx4 v37, s[16:19], s41 offen offset:0 lds
    buffer_load_dwordx4 v5, s[16:19], s41 offen offset:1024 lds
    buffer_load_dwordx4 v6, s[16:19], s41 offen offset:2048 lds
    v_mfma_f32_32x32x16_bf16 v[64:79], a[84:87], a[40:43], v[64:79]
    buffer_load_dwordx4 v7, s[16:19], s41 offen offset:3072 lds
    s_add_u32 m0, s40, 12288
    s_add_u32 s45, s45, 128
    v_mfma_f32_32x32x16_bf16 v[80:95], a[84:87], a[44:47], v[80:95]
    s_and_b32 s45, s45, 0xfffffbff
    buffer_load_dwordx4 v38, s[4:7], s45 offen lds
    buffer_load_dwordx4 v254, s[4:7], s45 offen offset:1024 lds
    s_waitcnt lgkmcnt(0)
    s_waitcnt vmcnt(12)
    s_barrier
    v_mfma_f32_32x32x16_bf16 v[64:79], a[88:91], a[48:51], v[64:79]
    ds_read_b64_tr_b16 a[64:65], v39 offset:32768
    ds_read_b64_tr_b16 a[66:67], v40 offset:32768
    ds_read_b128 a[0:3], v41 offset:36864
    ds_read_b128 a[4:7], v41 offset:37888
    v_mfma_f32_32x32x16_bf16 v[80:95], a[88:91], a[52:55], v[80:95]
    ds_read_b64_tr_b16 a[68:69], v39 offset:33792
    ds_read_b64_tr_b16 a[70:71], v40 offset:33792
    ds_read_b128 a[8:11], v42 offset:36864
    ds_read_b128 a[12:15], v42 offset:37888
    v_mfma_f32_32x32x16_bf16 v[64:79], a[92:95], a[56:59], v[64:79]
    ds_read_b64_tr_b16 a[72:73], v39 offset:34816
    ds_read_b64_tr_b16 a[74:75], v40 offset:34816
    ds_read_b128 a[16:19], v43 offset:36864
    ds_read_b128 a[20:23], v43 offset:37888
    v_mfma_f32_32x32x16_bf16 v[80:95], a[92:95], a[60:63], v[80:95]
    ds_read_b64_tr_b16 a[76:77], v39 offset:35840
    ds_read_b64_tr_b16 a[78:79], v40 offset:35840
    ds_read_b128 a[24:27], v44 offset:36864
    ds_read_b128 a[28:31], v44 offset:37888
    s_waitcnt lgkmcnt(8)
    v_mfma_f32_32x32x16_bf16 v[64:79], a[64:67], a[0:3], v[64:79]
    s_add_u32 m0, s40, 16384
    s_add_u32 s41, s41, 0x80000
    s_and_b32 s41, s41, 0x3fffff
    v_mfma_f32_32x32x16_bf16 v[80:95], a[64:67], a[4:7], v[80:95]
    buffer_load_dwordx4 v37, s[16:19], s41 offen offset:0 lds
    buffer_load_dwordx4 v5, s[16:19], s41 offen offset:1024 lds
    buffer_load_dwordx4 v6, s[16:19], s41 offen offset:2048 lds
    v_mfma_f32_32x32x16_bf16 v[64:79], a[68:71], a[8:11], v[64:79]
    buffer_load_dwordx4 v7, s[16:19], s41 offen offset:3072 lds
    s_add_u32 m0, s40, 20480
    s_add_u32 s45, s45, 128
    v_mfma_f32_32x32x16_bf16 v[80:95], a[68:71], a[12:15], v[80:95]
    s_and_b32 s45, s45, 0xfffffbff
    buffer_load_dwordx4 v38, s[4:7], s45 offen lds
    buffer_load_dwordx4 v254, s[4:7], s45 offen offset:1024 lds
    s_waitcnt lgkmcnt(0)
    s_waitcnt vmcnt(12)
    s_barrier
    v_mfma_f32_32x32x16_bf16 v[64:79], a[72:75], a[16:19], v[64:79]
    ds_read_b64_tr_b16 a[80:81], v39 offset:0
    ds_read_b64_tr_b16 a[82:83], v40 offset:0
    ds_read_b128 a[32:35], v41 offset:4096
    ds_read_b128 a[36:39], v41 offset:5120
    v_mfma_f32_32x32x16_bf16 v[80:95], a[72:75], a[20:23], v[80:95]
    ds_read_b64_tr_b16 a[84:85], v39 offset:1024
    ds_read_b64_tr_b16 a[86:87], v40 offset:1024
    ds_read_b128 a[40:43], v42 offset:4096
    ds_read_b128 a[44:47], v42 offset:5120
    v_mfma_f32_32x32x16_bf16 v[64:79], a[76:79], a[24:27], v[64:79]
    ds_read_b64_tr_b16 a[88:89], v39 offset:2048
    ds_read_b64_tr_b16 a[90:91], v40 offset:2048
    ds_read_b128 a[48:51], v43 offset:4096
    ds_read_b128 a[52:55], v43 offset:5120
    v_mfma_f32_32x32x16_bf16 v[80:95], a[76:79], a[28:31], v[80:95]
    ds_read_b64_tr_b16 a[92:93], v39 offset:3072
    ds_read_b64_tr_b16 a[94:95], v40 offset:3072
    ds_read_b128 a[56:59], v44 offset:4096
    ds_read_b128 a[60:63], v44 offset:5120
    s_waitcnt lgkmcnt(8)
    v_mfma_f32_32x32x16_bf16 v[64:79], a[80:83], a[32:35], v[64:79]
    buffer_load_dwordx2 v[58:59], v239, s[32:35], 0 offen sc1
    s_add_u32 m0, s40, 24576
    s_nop 0
    buffer_load_dwordx4 v32, s[8:11], s48 offen offset:0 lds
    buffer_load_dwordx4 v33, s[8:11], s48 offen offset:1024 lds
    buffer_load_dwordx4 v34, s[8:11], s48 offen offset:2048 lds
    v_mfma_f32_32x32x16_bf16 v[80:95], a[80:83], a[36:39], v[80:95]
    buffer_load_dwordx4 v35, s[8:11], s48 offen offset:3072 lds
    s_and_b32 s96, s2, 31
    s_lshl_b32 s97, s39, 21
    s_lshl_b32 s98, s96, 2
    s_add_u32 s98, s98, s36
    s_lshl_b32 s4, s98, 12
    s_add_u32 s4, s4, s97
    v_mfma_f32_32x32x16_bf16 v[64:79], a[84:87], a[40:43], v[64:79]
    s_add_u32 s16, s4, 0x80000
    s_lshl_b32 s5, s98, 7
    s_add_u32 s99, s97, 0x110000
    s_add_u32 s5, s5, s99
    s_lshl_b32 s6, s36, 7
    s_add_u32 s6, s6, s99
    v_mfma_f32_32x32x16_bf16 v[80:95], a[84:87], a[44:47], v[80:95]
    s_add_u32 s42, s38, s39
    s_and_b32 s42, s42, 3
    s_lshl_b32 s7, s38, 17
    s_lshl_b32 s98, s36, 12
    s_add_u32 s7, s7, s98
    s_lshl_b32 s99, s37, 9
    s_add_u32 s7, s7, s99
    s_waitcnt lgkmcnt(0)
    s_waitcnt vmcnt(11)
    s_barrier
    v_mfma_f32_32x32x16_bf16 v[64:79], a[88:91], a[48:51], v[64:79]
    ds_read_b64_tr_b16 a[64:65], v39 offset:8192
    ds_read_b64_tr_b16 a[66:67], v40 offset:8192
    ds_read_b128 a[0:3], v41 offset:12288
    ds_read_b128 a[4:7], v41 offset:13312
    v_mfma_f32_32x32x16_bf16 v[80:95], a[88:91], a[52:55], v[80:95]
    ds_read_b64_tr_b16 a[68:69], v39 offset:9216
    ds_read_b64_tr_b16 a[70:71], v40 offset:9216
    ds_read_b128 a[8:11], v42 offset:12288
    ds_read_b128 a[12:15], v42 offset:13312
    v_mfma_f32_32x32x16_bf16 v[64:79], a[92:95], a[56:59], v[64:79]
    ds_read_b64_tr_b16 a[72:73], v39 offset:10240
    ds_read_b64_tr_b16 a[74:75], v40 offset:10240
    ds_read_b128 a[16:19], v43 offset:12288
    ds_read_b128 a[20:23], v43 offset:13312
    v_mfma_f32_32x32x16_bf16 v[80:95], a[92:95], a[60:63], v[80:95]
    ds_read_b64_tr_b16 a[76:77], v39 offset:11264
    ds_read_b64_tr_b16 a[78:79], v40 offset:11264
    ds_read_b128 a[24:27], v44 offset:12288
    ds_read_b128 a[28:31], v44 offset:13312
    s_waitcnt lgkmcnt(8)
    v_mfma_f32_32x32x16_bf16 v[64:79], a[64:67], a[0:3], v[64:79]
    s_add_u32 m0, s40, 28672
    s_nop 0
    buffer_load_dwordx4 v32, s[8:11], s49 offen offset:0 lds
    buffer_load_dwordx4 v33, s[8:11], s49 offen offset:1024 lds
    buffer_load_dwordx4 v34, s[8:11], s49 offen offset:2048 lds
    buffer_load_dwordx4 v35, s[8:11], s49 offen offset:3072 lds
    v_mfma_f32_32x32x16_bf16 v[80:95], a[64:67], a[4:7], v[80:95]
    s_add_u32 s7, s7, s97
    s_add_u32 s7, s7, 0x80000
    s_lshl_b32 s18, s38, 14
    s_add_u32 s18, s18, s98
    s_add_u32 s18, s18, s97
    s_add_u32 s18, s18, 0x100000
    v_mfma_f32_32x32x16_bf16 v[64:79], a[68:71], a[8:11], v[64:79]
    s_add_u32 s17, s18, s99
    s_lshl_b32 s99, s37, 6
    s_add_u32 s18, s18, s99
    s_lshl_b32 s19, s39, 16
    s_lshl_b32 s99, s37, 13
    s_add_u32 s19, s19, s99
    v_mfma_f32_32x32x16_bf16 v[80:95], a[68:71], a[12:15], v[80:95]
    s_lshl_b32 s99, s42, 8
    s_add_u32 s19, s19, s99
    s_lshl_b32 s99, s36, 6
    s_add_u32 s19, s19, s99
    s_getreg_b32 s99, hwreg(HW_REG_XCC_ID, 0, 4)
    s_add_u32 s99, s99, 1
    s_lshl_b32 s99, s99, 24
    s_waitcnt lgkmcnt(0)
    s_waitcnt vmcnt(9)
    s_barrier
    v_mfma_f32_32x32x16_bf16 v[64:79], a[72:75], a[16:19], v[64:79]
    ds_read_b64_tr_b16 a[80:81], v39 offset:16384
    ds_read_b64_tr_b16 a[82:83], v40 offset:16384
    ds_read_b128 a[32:35], v41 offset:20480
    ds_read_b128 a[36:39], v41 offset:21504
    v_mfma_f32_32x32x16_bf16 v[80:95], a[72:75], a[20:23], v[80:95]
    ds_read_b64_tr_b16 a[84:85], v39 offset:17408
    ds_read_b64_tr_b16 a[86:87], v40 offset:17408
    ds_read_b128 a[40:43], v42 offset:20480
    ds_read_b128 a[44:47], v42 offset:21504
    v_mfma_f32_32x32x16_bf16 v[64:79], a[76:79], a[24:27], v[64:79]
    ds_read_b64_tr_b16 a[88:89], v39 offset:18432
    ds_read_b64_tr_b16 a[90:91], v40 offset:18432
    ds_read_b128 a[48:51], v43 offset:20480
    ds_read_b128 a[52:55], v43 offset:21504
    v_mfma_f32_32x32x16_bf16 v[80:95], a[76:79], a[28:31], v[80:95]
    ds_read_b64_tr_b16 a[92:93], v39 offset:19456
    ds_read_b64_tr_b16 a[94:95], v40 offset:19456
    ds_read_b128 a[56:59], v44 offset:20480
    ds_read_b128 a[60:63], v44 offset:21504
    s_waitcnt lgkmcnt(8)
    v_mfma_f32_32x32x16_bf16 v[64:79], a[80:83], a[32:35], v[64:79]
    v_mfma_f32_32x32x16_bf16 v[64:79], a[84:87], a[40:43], v[64:79]
    s_mov_b32 s96, 0x3e0293ee
    s_mov_b32 s97, 0x3e0293ee
    s_waitcnt lgkmcnt(0)
    v_mfma_f32_32x32x16_bf16 v[64:79], a[88:91], a[48:51], v[64:79]
    v_mfma_f32_32x32x16_bf16 v[64:79], a[92:95], a[56:59], v[64:79]
    v_mfma_f32_32x32x16_bf16 v[80:95], a[80:83], a[36:39], v[80:95]
    v_add_u32 v41, 0, v47
    v_add_u32 v42, 40960, v47
    v_add_u32 v43, 81920, v47
    v_add_u32 v44, 122880, v47
    v_mfma_f32_32x32x16_bf16 v[80:95], a[84:87], a[44:47], v[80:95]
    s_and_b32 s98, s36, 1
    s_lshl_b32 s98, s98, 13
    v_add_u32 v52, s98, v41
    v_add_u32 v53, s98, v42
    v_add_u32 v54, s98, v43
    v_add_u32 v55, s98, v44
    v_mfma_f32_32x32x16_bf16 v[80:95], a[88:91], a[52:55], v[80:95]
    v_pk_mul_f32 v[64:65], s[96:97], v[64:65]
    v_pk_mul_f32 v[66:67], s[96:97], v[66:67]
    v_pk_mul_f32 v[68:69], s[96:97], v[68:69]
    v_pk_mul_f32 v[70:71], s[96:97], v[70:71]
    v_pk_mul_f32 v[72:73], s[96:97], v[72:73]
    v_pk_mul_f32 v[74:75], s[96:97], v[74:75]
    v_mfma_f32_32x32x16_bf16 v[80:95], a[92:95], a[60:63], v[80:95]
    v_pk_mul_f32 v[76:77], s[96:97], v[76:77]
    v_pk_mul_f32 v[78:79], s[96:97], v[78:79]
    v_cvt_pk_bf16_f32 v128, v64, v65
    v_cvt_pk_bf16_f32 v129, v66, v67
    v_cvt_pk_bf16_f32 v130, v68, v69
    v_cvt_pk_bf16_f32 v131, v70, v71
    v_cvt_pk_bf16_f32 v132, v72, v73
    v_cvt_pk_bf16_f32 v133, v74, v75
    v_cvt_pk_bf16_f32 v134, v76, v77
    v_cvt_pk_bf16_f32 v135, v78, v79
    ds_write_b128 v247, v[128:131] offset:14336
    ds_write_b128 v247, v[132:135] offset:15360
    s_add_u32 m0, s40, 32768
    s_nop 0
    buffer_load_dwordx4 v32, s[8:11], s50 offen offset:0 lds
    buffer_load_dwordx4 v33, s[8:11], s50 offen offset:1024 lds
    v_pk_mul_f32 v[80:81], s[96:97], v[80:81]
    v_pk_mul_f32 v[82:83], s[96:97], v[82:83]
    v_pk_mul_f32 v[84:85], s[96:97], v[84:85]
    v_pk_mul_f32 v[86:87], s[96:97], v[86:87]
    v_pk_mul_f32 v[88:89], s[96:97], v[88:89]
    v_pk_mul_f32 v[90:91], s[96:97], v[90:91]
    v_pk_mul_f32 v[92:93], s[96:97], v[92:93]
    v_pk_mul_f32 v[94:95], s[96:97], v[94:95]
    v_cvt_pk_bf16_f32 v136, v80, v81
    v_cvt_pk_bf16_f32 v137, v82, v83
    v_cvt_pk_bf16_f32 v138, v84, v85
    v_cvt_pk_bf16_f32 v139, v86, v87
    v_cvt_pk_bf16_f32 v140, v88, v89
    v_cvt_pk_bf16_f32 v141, v90, v91
    v_cvt_pk_bf16_f32 v142, v92, v93
    v_cvt_pk_bf16_f32 v143, v94, v95
    ds_write_b128 v247, v[136:139] offset:22528
    ds_write_b128 v247, v[140:143] offset:23552
    buffer_load_dwordx4 v34, s[8:11], s50 offen offset:2048 lds
    buffer_load_dwordx4 v35, s[8:11], s50 offen offset:3072 lds
    s_add_u32 m0, s40, 36864
    s_nop 0
    buffer_load_dwordx4 v32, s[8:11], s51 offen offset:0 lds
    buffer_load_dwordx4 v33, s[8:11], s51 offen offset:1024 lds
    buffer_load_dwordx4 v34, s[8:11], s51 offen offset:2048 lds
    buffer_load_dwordx4 v35, s[8:11], s51 offen offset:3072 lds
    s_waitcnt vmcnt(8)
    ds_read_b128 a[96:99], v8 offset:24576
    ds_read_b128 a[100:103], v9 offset:24576
    ds_read_b128 a[104:107], v10 offset:24576
    ds_read_b128 a[108:111], v11 offset:24576
    ds_read_b128 a[112:115], v12 offset:24576
    ds_read_b128 a[116:119], v13 offset:24576
    ds_read_b128 a[120:123], v14 offset:24576
    ds_read_b128 a[124:127], v15 offset:24576
    s_waitcnt lgkmcnt(8)
    s_barrier
    ds_read_b128 a[64:67], v52 offset:14336
    ds_read_b128 a[68:71], v52 offset:15360
    ds_read_b128 a[72:75], v53 offset:14336
    ds_read_b128 a[76:79], v53 offset:15360
    ds_read_b128 a[80:83], v54 offset:14336
    ds_read_b128 a[84:87], v54 offset:15360
    ds_read_b128 a[88:91], v55 offset:14336
    ds_read_b128 a[92:95], v55 offset:15360
    v_cmp_eq_u32 vcc, 0, v58
    s_cbranch_vccnz K_noncewait
K_nonceok:
    s_waitcnt lgkmcnt(4)
    s_add_u32 m0, s40, 0
    v_mfma_f32_32x32x16_bf16 v[112:127], a[96:99], a[64:67], 0
    ds_read_b128 a[224:227], v16 offset:24576
    ds_read_b128 a[228:231], v17 offset:24576
    buffer_load_dwordx4 v32, s[8:11], s52 offen offset:0 lds
    v_mfma_f32_32x32x16_bf16 v[112:127], a[100:103], a[68:71], v[112:127]
    buffer_load_dwordx4 v33, s[8:11], s52 offen offset:1024 lds
    v_mfma_f32_32x32x16_bf16 v[112:127], a[104:107], a[72:75], v[112:127]
    ds_read_b128 a[232:235], v18 offset:24576
    ds_read_b128 a[236:239], v19 offset:24576
    buffer_load_dwordx4 v34, s[8:11], s52 offen offset:2048 lds
    v_mfma_f32_32x32x16_bf16 v[112:127], a[108:111], a[76:79], v[112:127]
    buffer_load_dwordx4 v35, s[8:11], s52 offen offset:3072 lds
    s_waitcnt lgkmcnt(4)
    s_add_u32 m0, s40, 4096
    v_mfma_f32_32x32x16_bf16 v[112:127], a[112:115], a[80:83], v[112:127]
    ds_read_b128 a[240:243], v20 offset:24576
    ds_read_b128 a[244:247], v21 offset:24576
    buffer_load_dwordx4 v32, s[8:11], s53 offen offset:0 lds
    v_mfma_f32_32x32x16_bf16 v[112:127], a[116:119], a[84:87], v[112:127]
    buffer_load_dwordx4 v33, s[8:11], s53 offen offset:1024 lds
    v_mfma_f32_32x32x16_bf16 v[112:127], a[120:123], a[88:91], v[112:127]
    ds_read_b128 a[248:251], v22 offset:24576
    ds_read_b128 a[252:255], v23 offset:24576
    buffer_load_dwordx4 v34, s[8:11], s53 offen offset:2048 lds
    v_mfma_f32_32x32x16_bf16 v[112:127], a[124:127], a[92:95], v[112:127]
    buffer_load_dwordx4 v35, s[8:11], s53 offen offset:3072 lds
    s_waitcnt lgkmcnt(4)
    v_mfma_f32_32x32x16_bf16 v[80:95], a[224:227], a[64:67], 0
    v_mov_b32 v232, v58
    v_xor_b32 v233, s99, v59
    v_and_b32 v52, 3, v1
    v_lshlrev_b32 v52, 4, v52
    v_lshrrev_b64 v[54:55], v52, v[58:59]
    v_lshlrev_b32 v234, 16, v54
    s_mov_b64 exec, 1
    buffer_store_dwordx2 v[232:233], v239, s[20:23], s5 offen offset:64 sc1
    s_mov_b64 exec, -1
    s_nop 0
    v_mfma_f32_32x32x16_bf16 v[80:95], a[228:231], a[68:71], v[80:95]
    v_max3_f32 v46, v112, v113, v114
    v_max3_f32 v46, v46, v115, v116
    v_max3_f32 v46, v46, v117, v118
    v_max3_f32 v46, v46, v119, v120
    v_mfma_f32_32x32x16_bf16 v[80:95], a[232:235], a[72:75], v[80:95]
    v_max3_f32 v46, v46, v121, v122
    v_max3_f32 v46, v46, v123, v124
    v_max3_f32 v46, v46, v125, v126
    v_max_f32 v46, v46, v127
    v_mfma_f32_32x32x16_bf16 v[80:95], a[236:239], a[76:79], v[80:95]
    v_mov_b32 v48, v46
    v_mov_b32 v49, v46
    s_nop 1
    v_permlane32_swap_b32 v48, v49
    s_waitcnt lgkmcnt(0)
    s_waitcnt vmcnt(9)
    s_add_u32 m0, s40, 8192
    v_mfma_f32_32x32x16_bf16 v[80:95], a[240:243], a[80:83], v[80:95]
    ds_read_b128 a[96:99], v8 offset:32768
    ds_read_b128 a[100:103], v9 offset:32768
    buffer_load_dwordx4 v36, s[12:15], s48 offen offset:0 lds
    s_nop 1
    v_min_f32 v96, -v48, -v49
    v_min_f32 v97, -v48, -v49
    v_mov_b64 v[98:99], v[96:97]
    v_mov_b64 v[100:101], v[96:97]
    v_mfma_f32_32x32x16_bf16 v[80:95], a[244:247], a[84:87], v[80:95]
    ds_read_b128 a[104:107], v10 offset:32768
    ds_read_b128 a[108:111], v11 offset:32768
    buffer_load_dwordx4 v36, s[12:15], s48 offen offset:1024 lds
    v_mov_b64 v[102:103], v[96:97]
    v_mov_b64 v[104:105], v[96:97]
    v_mov_b64 v[106:107], v[96:97]
    v_mov_b64 v[108:109], v[96:97]
    v_mfma_f32_32x32x16_bf16 v[80:95], a[248:251], a[88:91], v[80:95]
    ds_read_b128 a[112:115], v12 offset:32768
    ds_read_b128 a[116:119], v13 offset:32768
    buffer_load_dwordx4 v36, s[12:15], s48 offen offset:2048 lds
    v_mov_b64 v[110:111], v[96:97]
    v_pk_add_f32 v[112:113], v[112:113], v[96:97]
    v_pk_add_f32 v[114:115], v[114:115], v[96:97]
    v_pk_add_f32 v[116:117], v[116:117], v[96:97]
    v_mfma_f32_32x32x16_bf16 v[80:95], a[252:255], a[92:95], v[80:95]
    ds_read_b128 a[120:123], v14 offset:32768
    ds_read_b128 a[124:127], v15 offset:32768
    buffer_load_dwordx4 v36, s[12:15], s48 offen offset:3072 lds
    v_pk_add_f32 v[118:119], v[118:119], v[96:97]
    v_pk_add_f32 v[120:121], v[120:121], v[96:97]
    v_pk_add_f32 v[122:123], v[122:123], v[96:97]
    v_pk_add_f32 v[124:125], v[124:125], v[96:97]
    v_pk_add_f32 v[126:127], v[126:127], v[96:97]
    s_barrier
    s_waitcnt lgkmcnt(4)
    v_mfma_f32_32x32x16_bf16 v[64:79], a[96:99], a[64:67], v[96:111]
    ds_read_b128 a[224:227], v16 offset:32768
    ds_read_b128 a[228:231], v17 offset:32768
    v_exp_f32 v224, v112
    v_exp_f32 v225, v113
    v_exp_f32 v226, v114
    v_add_f32 v228, v224, v225
    v_cvt_pk_bf16_f32 v128, v224, v225
    v_exp_f32 v227, v115
    v_add_f32 v228, v228, v226
    s_add_u32 m0, s40, 12288
    v_mfma_f32_32x32x16_bf16 v[64:79], a[100:103], a[68:71], v[64:79]
    buffer_load_dwordx4 v36, s[12:15], s49 offen offset:0 lds
    v_exp_f32 v224, v116
    v_add_f32 v228, v228, v227
    v_cvt_pk_bf16_f32 v129, v226, v227
    v_exp_f32 v225, v117
    v_add_f32 v228, v228, v224
    v_mfma_f32_32x32x16_bf16 v[64:79], a[104:107], a[72:75], v[64:79]
    ds_read_b128 a[232:235], v18 offset:32768
    ds_read_b128 a[236:239], v19 offset:32768
    v_exp_f32 v226, v118
    v_add_f32 v228, v228, v225
    v_cvt_pk_bf16_f32 v130, v224, v225
    v_exp_f32 v227, v119
    v_add_f32 v228, v228, v226
    v_pk_add_f32 v[80:81], v[80:81], v[96:97]
    v_pk_add_f32 v[82:83], v[82:83], v[96:97]
    v_mfma_f32_32x32x16_bf16 v[64:79], a[108:111], a[76:79], v[64:79]
    buffer_load_dwordx4 v36, s[12:15], s49 offen offset:1024 lds
    v_exp_f32 v224, v120
    v_add_f32 v228, v228, v227
    v_cvt_pk_bf16_f32 v131, v226, v227
    v_exp_f32 v225, v121
    v_add_f32 v228, v228, v224
    v_pk_add_f32 v[84:85], v[84:85], v[96:97]
    v_pk_add_f32 v[86:87], v[86:87], v[96:97]
    s_waitcnt lgkmcnt(4)
    v_mfma_f32_32x32x16_bf16 v[64:79], a[112:115], a[80:83], v[64:79]
    ds_read_b128 a[240:243], v20 offset:32768
    ds_read_b128 a[244:247], v21 offset:32768
    v_exp_f32 v226, v122
    v_add_f32 v228, v228, v225
    v_cvt_pk_bf16_f32 v132, v224, v225
    v_exp_f32 v227, v123
    v_add_f32 v228, v228, v226
    v_pk_add_f32 v[88:89], v[88:89], v[96:97]
    v_pk_add_f32 v[90:91], v[90:91], v[96:97]
    v_mfma_f32_32x32x16_bf16 v[64:79], a[116:119], a[84:87], v[64:79]
    buffer_load_dwordx4 v36, s[12:15], s49 offen offset:2048 lds
    v_exp_f32 v224, v124
    v_add_f32 v228, v228, v227
    v_cvt_pk_bf16_f32 v133, v226, v227
    v_exp_f32 v225, v125
    v_add_f32 v228, v228, v224
    v_pk_add_f32 v[92:93], v[92:93], v[96:97]
    v_pk_add_f32 v[94:95], v[94:95], v[96:97]
    v_mfma_f32_32x32x16_bf16 v[64:79], a[120:123], a[88:91], v[64:79]
    ds_read_b128 a[248:251], v22 offset:32768
    ds_read_b128 a[252:255], v23 offset:32768
    v_exp_f32 v226, v126
    v_add_f32 v228, v228, v225
    v_cvt_pk_bf16_f32 v134, v224, v225
    v_exp_f32 v227, v127
    v_add_f32 v228, v228, v226
    v_mfma_f32_32x32x16_bf16 v[64:79], a[124:127], a[92:95], v[64:79]
    buffer_load_dwordx4 v36, s[12:15], s49 offen offset:3072 lds
    v_exp_f32 v224, v80
    v_add_f32 v228, v228, v227
    v_cvt_pk_bf16_f32 v135, v226, v227
    v_exp_f32 v225, v81
    v_exp_f32 v226, v82
    v_mov_b32 v45, v228
    v_add_f32 v228, v224, v225
    v_cvt_pk_bf16_f32 v136, v224, v225
    v_exp_f32 v227, v83
    v_add_f32 v228, v228, v226
    v_exp_f32 v224, v84
    v_add_f32 v228, v228, v227
    v_cvt_pk_bf16_f32 v137, v226, v227
    v_exp_f32 v225, v85
    v_add_f32 v228, v228, v224
    v_exp_f32 v226, v86
    v_add_f32 v228, v228, v225
    v_cvt_pk_bf16_f32 v138, v224, v225
    v_exp_f32 v227, v87
    v_add_f32 v228, v228, v226
    v_exp_f32 v224, v88
    v_add_f32 v228, v228, v227
    v_cvt_pk_bf16_f32 v139, v226, v227
    v_exp_f32 v225, v89
    v_add_f32 v228, v228, v224
    v_exp_f32 v226, v90
    v_add_f32 v228, v228, v225
    v_cvt_pk_bf16_f32 v140, v224, v225
    v_exp_f32 v227, v91
    v_add_f32 v228, v228, v226
    v_exp_f32 v224, v92
    v_add_f32 v228, v228, v227
    v_cvt_pk_bf16_f32 v141, v226, v227
    v_exp_f32 v225, v93
    v_add_f32 v228, v228, v224
    v_exp_f32 v226, v94
    v_add_f32 v228, v228, v225
    v_cvt_pk_bf16_f32 v142, v224, v225
    v_exp_f32 v227, v95
    v_add_f32 v228, v228, v226
    v_exp_f32 v224, v64
    v_add_f32 v228, v228, v227
    v_cvt_pk_bf16_f32 v143, v226, v227
    v_cmp_nge_f32 vcc, s44, v228
    v_exp_f32 v225, v65
    s_cbranch_vccnz K_rare_1
K_back_1:
    s_waitcnt lgkmcnt(0)
    v_mfma_f32_32x32x16_bf16 v[80:95], a[224:227], a[64:67], v[96:111]
    v_exp_f32 v226, v66
    v_add_f32 v45, v45, v228
    v_add_f32 v228, v224, v225
    v_cvt_pk_bf16_f32 v144, v224, v225
    v_exp_f32 v227, v67
    v_add_f32 v228, v228, v226
    v_mfma_f32_32x32x16_bf16 v[80:95], a[228:231], a[68:71], v[80:95]
    v_exp_f32 v224, v68
    v_add_f32 v228, v228, v227
    v_cvt_pk_bf16_f32 v145, v226, v227
    v_exp_f32 v225, v69
    v_add_f32 v228, v228, v224
    v_mfma_f32_32x32x16_bf16 v[80:95], a[232:235], a[72:75], v[80:95]
    v_exp_f32 v226, v70
    v_add_f32 v228, v228, v225
    v_cvt_pk_bf16_f32 v146, v224, v225
    v_mfma_f32_32x32x16_bf16 v[80:95], a[236:239], a[76:79], v[80:95]
    v_exp_f32 v227, v71
    v_add_f32 v228, v228, v226
    s_waitcnt vmcnt(9)
    s_add_u32 m0, s40, 24576
    v_mfma_f32_32x32x16_bf16 v[80:95], a[240:243], a[80:83], v[80:95]
    ds_read_b128 a[96:99], v8 offset:0
    ds_read_b128 a[100:103], v9 offset:0
    buffer_load_dwordx4 v32, s[8:11], s54 offen offset:0 lds
    v_exp_f32 v224, v72
    v_add_f32 v228, v228, v227
    v_cvt_pk_bf16_f32 v147, v226, v227
    v_mfma_f32_32x32x16_bf16 v[80:95], a[244:247], a[84:87], v[80:95]
    ds_read_b128 a[104:107], v10 offset:0
    ds_read_b128 a[108:111], v11 offset:0
    buffer_load_dwordx4 v33, s[8:11], s54 offen offset:1024 lds
    v_exp_f32 v225, v73
    v_add_f32 v228, v228, v224
    v_mfma_f32_32x32x16_bf16 v[80:95], a[248:251], a[88:91], v[80:95]
    ds_read_b128 a[112:115], v12 offset:0
    ds_read_b128 a[116:119], v13 offset:0
    buffer_load_dwordx4 v34, s[8:11], s54 offen offset:2048 lds
    v_exp_f32 v226, v74
    v_add_f32 v228, v228, v225
    v_cvt_pk_bf16_f32 v148, v224, v225
    v_mfma_f32_32x32x16_bf16 v[80:95], a[252:255], a[92:95], v[80:95]
    ds_read_b128 a[120:123], v14 offset:0
    ds_read_b128 a[124:127], v15 offset:0
    buffer_load_dwordx4 v35, s[8:11], s54 offen offset:3072 lds
    v_exp_f32 v227, v75
    v_add_f32 v228, v228, v226
    v_exp_f32 v224, v76
    v_add_f32 v228, v228, v227
    v_cvt_pk_bf16_f32 v149, v226, v227
    v_exp_f32 v225, v77
    v_add_f32 v228, v228, v224
    v_exp_f32 v226, v78
    v_add_f32 v228, v228, v225
    v_cvt_pk_bf16_f32 v150, v224, v225
    v_exp_f32 v227, v79
    v_add_f32 v228, v228, v226
    v_exp_f32 v224, v80
    v_add_f32 v228, v228, v227
    v_cvt_pk_bf16_f32 v151, v226, v227
    v_cmp_nge_f32 vcc, s44, v228
    v_exp_f32 v225, v81
    s_cbranch_vccnz K_rare_2
K_back_2:
    s_add_u32 m0, s40, 28672
    s_nop 0
    buffer_load_dwordx4 v32, s[8:11], s55 offen offset:0 lds
    buffer_load_dwordx4 v33, s[8:11], s55 offen offset:1024 lds
    buffer_load_dwordx4 v34, s[8:11], s55 offen offset:2048 lds
    buffer_load_dwordx4 v35, s[8:11], s55 offen offset:3072 lds
    s_waitcnt lgkmcnt(0)
    v_mfma_f32_32x32x16_bf16 v[64:79], a[96:99], a[64:67], v[96:111]
    v_exp_f32 v226, v82
    v_add_f32 v45, v45, v228
    v_add_f32 v228, v224, v225
    v_cvt_pk_bf16_f32 v152, v224, v225
    v_mfma_f32_32x32x16_bf16 v[64:79], a[100:103], a[68:71], v[64:79]
    v_exp_f32 v227, v83
    v_add_f32 v228, v228, v226
    s_waitcnt vmcnt(8)
    s_barrier
    v_mfma_f32_32x32x16_bf16 v[64:79], a[104:107], a[72:75], v[64:79]
    ds_read_b64_tr_b16 a[224:225], v24 offset:8192
    ds_read_b64_tr_b16 a[226:227], v24 offset:10240
    ds_read_b64_tr_b16 a[228:229], v25 offset:8192
    ds_read_b64_tr_b16 a[230:231], v25 offset:10240
    v_exp_f32 v224, v84
    v_add_f32 v228, v228, v227
    v_cvt_pk_bf16_f32 v153, v226, v227
    v_mfma_f32_32x32x16_bf16 v[64:79], a[108:111], a[76:79], v[64:79]
    ds_read_b64_tr_b16 a[232:233], v26 offset:8192
    ds_read_b64_tr_b16 a[234:235], v26 offset:10240
    ds_read_b64_tr_b16 a[236:237], v27 offset:8192
    ds_read_b64_tr_b16 a[238:239], v27 offset:10240
    v_exp_f32 v225, v85
    v_add_f32 v228, v228, v224
    s_add_u32 m0, s40, 16384
    v_mfma_f32_32x32x16_bf16 v[64:79], a[112:115], a[80:83], v[64:79]
    ds_read_b64_tr_b16 a[240:241], v24 offset:12288
    ds_read_b64_tr_b16 a[242:243], v24 offset:14336
    ds_read_b64_tr_b16 a[244:245], v25 offset:12288
    ds_read_b64_tr_b16 a[246:247], v25 offset:14336
    buffer_load_dwordx4 v36, s[12:15], s50 offen offset:0 lds
    v_exp_f32 v226, v86
    v_add_f32 v228, v228, v225
    v_cvt_pk_bf16_f32 v154, v224, v225
    v_mfma_f32_32x32x16_bf16 v[64:79], a[116:119], a[84:87], v[64:79]
    ds_read_b64_tr_b16 a[248:249], v26 offset:12288
    ds_read_b64_tr_b16 a[250:251], v26 offset:14336
    ds_read_b64_tr_b16 a[252:253], v27 offset:12288
    ds_read_b64_tr_b16 a[254:255], v27 offset:14336
    buffer_load_dwordx4 v36, s[12:15], s50 offen offset:1024 lds
    v_exp_f32 v227, v87
    v_add_f32 v228, v228, v226
    v_mfma_f32_32x32x16_bf16 v[64:79], a[120:123], a[88:91], v[64:79]
    ds_read_b128 a[96:99], v16 offset:0
    ds_read_b128 a[100:103], v17 offset:0
    buffer_load_dwordx4 v36, s[12:15], s50 offen offset:2048 lds
    v_exp_f32 v224, v88
    v_add_f32 v228, v228, v227
    v_cvt_pk_bf16_f32 v155, v226, v227
    v_mfma_f32_32x32x16_bf16 v[64:79], a[124:127], a[92:95], v[64:79]
    ds_read_b128 a[104:107], v18 offset:0
    buffer_load_dwordx4 v36, s[12:15], s50 offen offset:3072 lds
    v_exp_f32 v225, v89
    v_add_f32 v228, v228, v224
    s_waitcnt lgkmcnt(11)
    s_add_u32 m0, s40, 20480
    v_mfma_f32_32x32x16_bf16 v[160:175], a[224:227], v[128:131], 0
    ds_read_b128 a[108:111], v19 offset:0
    ds_read_b128 a[112:115], v20 offset:0
    buffer_load_dwordx4 v36, s[12:15], s51 offen offset:0 lds
    v_exp_f32 v226, v90
    v_add_f32 v228, v228, v225
    v_cvt_pk_bf16_f32 v156, v224, v225
    v_mfma_f32_32x32x16_bf16 v[176:191], a[228:231], v[128:131], 0
    ds_read_b128 a[116:119], v21 offset:0
    buffer_load_dwordx4 v36, s[12:15], s51 offen offset:1024 lds
    v_exp_f32 v227, v91
    v_add_f32 v228, v228, v226
    v_mfma_f32_32x32x16_bf16 v[192:207], a[232:235], v[128:131], 0
    ds_read_b128 a[120:123], v22 offset:0
    ds_read_b128 a[124:127], v23 offset:0
    buffer_load_dwordx4 v36, s[12:15], s51 offen offset:2048 lds
    v_exp_f32 v224, v92
    v_add_f32 v228, v228, v227
    v_cvt_pk_bf16_f32 v157, v226, v227
    s_waitcnt lgkmcnt(8)
    v_mfma_f32_32x32x16_bf16 v[208:223], a[236:239], v[128:131], 0
    ds_read_b64_tr_b16 a[224:225], v28 offset:8192
    buffer_load_dwordx4 v36, s[12:15], s51 offen offset:3072 lds
    v_exp_f32 v225, v93
    v_add_f32 v228, v228, v224
    v_mfma_f32_32x32x16_bf16 v[160:175], a[240:243], v[132:135], v[160:175]
    ds_read_b64_tr_b16 a[226:227], v28 offset:10240
    ds_read_b64_tr_b16 a[228:229], v29 offset:8192
    v_exp_f32 v226, v94
    v_add_f32 v228, v228, v225
    v_cvt_pk_bf16_f32 v158, v224, v225
    s_add_u32 m0, s40, 32768
    v_mfma_f32_32x32x16_bf16 v[176:191], a[244:247], v[132:135], v[176:191]
    ds_read_b64_tr_b16 a[230:231], v29 offset:10240
    buffer_load_dwordx4 v32, s[8:11], s56 offen offset:0 lds
    v_exp_f32 v227, v95
    v_add_f32 v228, v228, v226
    v_mfma_f32_32x32x16_bf16 v[192:207], a[248:251], v[132:135], v[192:207]
    ds_read_b64_tr_b16 a[232:233], v30 offset:8192
    ds_read_b64_tr_b16 a[234:235], v30 offset:10240
    v_exp_f32 v224, v64
    v_add_f32 v228, v228, v227
    v_cvt_pk_bf16_f32 v159, v226, v227
    v_mfma_f32_32x32x16_bf16 v[208:223], a[252:255], v[132:135], v[208:223]
    ds_read_b64_tr_b16 a[236:237], v31 offset:8192
    buffer_load_dwordx4 v33, s[8:11], s56 offen offset:1024 lds
    v_cmp_nge_f32 vcc, s44, v228
    v_exp_f32 v225, v65
    s_cbranch_vccnz K_rare_3
K_back_3:
    s_waitcnt lgkmcnt(7)
    v_mfma_f32_32x32x16_bf16 v[80:95], a[96:99], a[64:67], v[96:111]
    ds_read_b64_tr_b16 a[238:239], v31 offset:10240
    ds_read_b64_tr_b16 a[240:241], v28 offset:12288
    v_exp_f32 v226, v66
    v_add_f32 v45, v45, v228
    v_add_f32 v228, v224, v225
    v_cvt_pk_bf16_f32 v128, v224, v225
    v_mfma_f32_32x32x16_bf16 v[80:95], a[100:103], a[68:71], v[80:95]
    ds_read_b64_tr_b16 a[242:243], v28 offset:14336
    buffer_load_dwordx4 v34, s[8:11], s56 offen offset:2048 lds
    v_exp_f32 v227, v67
    v_add_f32 v228, v228, v226
    v_mfma_f32_32x32x16_bf16 v[80:95], a[104:107], a[72:75], v[80:95]
    ds_read_b64_tr_b16 a[244:245], v29 offset:12288
    ds_read_b64_tr_b16 a[246:247], v29 offset:14336
    v_exp_f32 v224, v68
    v_add_f32 v228, v228, v227
    v_cvt_pk_bf16_f32 v129, v226, v227
    v_mfma_f32_32x32x16_bf16 v[80:95], a[108:111], a[76:79], v[80:95]
    ds_read_b64_tr_b16 a[248:249], v30 offset:12288
    buffer_load_dwordx4 v35, s[8:11], s56 offen offset:3072 lds
    v_exp_f32 v225, v69
    v_add_f32 v228, v228, v224
    v_mfma_f32_32x32x16_bf16 v[80:95], a[112:115], a[80:83], v[80:95]
    ds_read_b64_tr_b16 a[250:251], v30 offset:14336
    ds_read_b64_tr_b16 a[252:253], v31 offset:12288
    v_exp_f32 v226, v70
    v_add_f32 v228, v228, v225
    v_cvt_pk_bf16_f32 v130, v224, v225
    s_add_u32 m0, s40, 36864
    v_mfma_f32_32x32x16_bf16 v[80:95], a[116:119], a[84:87], v[80:95]
    ds_read_b64_tr_b16 a[254:255], v31 offset:14336
    buffer_load_dwordx4 v32, s[8:11], s57 offen offset:0 lds
    v_exp_f32 v227, v71
    v_add_f32 v228, v228, v226
    s_waitcnt vmcnt(13)
    v_mfma_f32_32x32x16_bf16 v[80:95], a[120:123], a[88:91], v[80:95]
    ds_read_b128 a[96:99], v8 offset:24576
    ds_read_b128 a[100:103], v9 offset:24576
    v_exp_f32 v224, v72
    v_add_f32 v228, v228, v227
    v_cvt_pk_bf16_f32 v131, v226, v227
    v_mfma_f32_32x32x16_bf16 v[80:95], a[124:127], a[92:95], v[80:95]
    ds_read_b128 a[104:107], v10 offset:24576
    buffer_load_dwordx4 v33, s[8:11], s57 offen offset:1024 lds
    v_exp_f32 v225, v73
    v_add_f32 v228, v228, v224
    s_waitcnt lgkmcnt(11)
    v_mfma_f32_32x32x16_bf16 v[160:175], a[224:227], v[136:139], v[160:175]
    ds_read_b128 a[108:111], v11 offset:24576
    ds_read_b128 a[112:115], v12 offset:24576
    v_exp_f32 v226, v74
    v_add_f32 v228, v228, v225
    v_cvt_pk_bf16_f32 v132, v224, v225
    v_mfma_f32_32x32x16_bf16 v[176:191], a[228:231], v[136:139], v[176:191]
    ds_read_b128 a[116:119], v13 offset:24576
    buffer_load_dwordx4 v34, s[8:11], s57 offen offset:2048 lds
    v_exp_f32 v227, v75
    v_add_f32 v228, v228, v226
    v_mfma_f32_32x32x16_bf16 v[192:207], a[232:235], v[136:139], v[192:207]
    ds_read_b128 a[120:123], v14 offset:24576
    ds_read_b128 a[124:127], v15 offset:24576
    v_exp_f32 v224, v76
    v_add_f32 v228, v228, v227
    v_cvt_pk_bf16_f32 v133, v226, v227
    s_waitcnt lgkmcnt(8)
    s_waitcnt vmcnt(7)
    s_barrier
    v_mfma_f32_32x32x16_bf16 v[208:223], a[236:239], v[136:139], v[208:223]
    ds_read_b64_tr_b16 a[224:225], v24 offset:16384
    buffer_load_dwordx4 v35, s[8:11], s57 offen offset:3072 lds
    v_exp_f32 v225, v77
    v_add_f32 v228, v228, v224
    v_mfma_f32_32x32x16_bf16 v[160:175], a[240:243], v[140:143], v[160:175]
    ds_read_b64_tr_b16 a[226:227], v24 offset:18432
    ds_read_b64_tr_b16 a[228:229], v25 offset:16384
    v_exp_f32 v226, v78
    v_add_f32 v228, v228, v225
    v_cvt_pk_bf16_f32 v134, v224, v225
    s_add_u32 m0, s40, 8192
    v_mfma_f32_32x32x16_bf16 v[176:191], a[244:247], v[140:143], v[176:191]
    ds_read_b64_tr_b16 a[230:231], v25 offset:18432
    buffer_load_dwordx4 v36, s[12:15], s52 offen offset:0 lds
    v_exp_f32 v227, v79
    v_add_f32 v228, v228, v226
    v_mfma_f32_32x32x16_bf16 v[192:207], a[248:251], v[140:143], v[192:207]
    ds_read_b64_tr_b16 a[232:233], v26 offset:16384
    ds_read_b64_tr_b16 a[234:235], v26 offset:18432
    v_exp_f32 v224, v80
    v_add_f32 v228, v228, v227
    v_cvt_pk_bf16_f32 v135, v226, v227
    v_mfma_f32_32x32x16_bf16 v[208:223], a[252:255], v[140:143], v[208:223]
    ds_read_b64_tr_b16 a[236:237], v27 offset:16384
    buffer_load_dwordx4 v36, s[12:15], s52 offen offset:1024 lds
    v_cmp_nge_f32 vcc, s44, v228
    v_exp_f32 v225, v81
    s_cbranch_vccnz K_rare_4
K_back_4:
    s_waitcnt lgkmcnt(7)
    v_mfma_f32_32x32x16_bf16 v[64:79], a[96:99], a[64:67], v[96:111]
    ds_read_b64_tr_b16 a[238:239], v27 offset:18432
    ds_read_b64_tr_b16 a[240:241], v24 offset:20480
    v_exp_f32 v226, v82
    v_add_f32 v45, v45, v228
    v_add_f32 v228, v224, v225
    v_cvt_pk_bf16_f32 v136, v224, v225
    v_mfma_f32_32x32x16_bf16 v[64:79], a[100:103], a[68:71], v[64:79]
    ds_read_b64_tr_b16 a[242:243], v24 offset:22528
    buffer_load_dwordx4 v36, s[12:15], s52 offen offset:2048 lds
    v_exp_f32 v227, v83
    v_add_f32 v228, v228, v226
    v_mfma_f32_32x32x16_bf16 v[64:79], a[104:107], a[72:75], v[64:79]
    ds_read_b64_tr_b16 a[244:245], v25 offset:20480
    ds_read_b64_tr_b16 a[246:247], v25 offset:22528
    v_exp_f32 v224, v84
    v_add_f32 v228, v228, v227
    v_cvt_pk_bf16_f32 v137, v226, v227
    v_mfma_f32_32x32x16_bf16 v[64:79], a[108:111], a[76:79], v[64:79]
    ds_read_b64_tr_b16 a[248:249], v26 offset:20480
    buffer_load_dwordx4 v36, s[12:15], s52 offen offset:3072 lds
    v_exp_f32 v225, v85
    v_add_f32 v228, v228, v224
    v_mfma_f32_32x32x16_bf16 v[64:79], a[112:115], a[80:83], v[64:79]
    ds_read_b64_tr_b16 a[250:251], v26 offset:22528
    ds_read_b64_tr_b16 a[252:253], v27 offset:20480
    v_exp_f32 v226, v86
    v_add_f32 v228, v228, v225
    v_cvt_pk_bf16_f32 v138, v224, v225
    s_add_u32 m0, s40, 12288
    v_mfma_f32_32x32x16_bf16 v[64:79], a[116:119], a[84:87], v[64:79]
    ds_read_b64_tr_b16 a[254:255], v27 offset:22528
    buffer_load_dwordx4 v36, s[12:15], s53 offen offset:0 lds
    v_exp_f32 v227, v87
    v_add_f32 v228, v228, v226
    v_mfma_f32_32x32x16_bf16 v[64:79], a[120:123], a[88:91], v[64:79]
    ds_read_b128 a[96:99], v16 offset:24576
    ds_read_b128 a[100:103], v17 offset:24576
    v_exp_f32 v224, v88
    v_add_f32 v228, v228, v227
    v_cvt_pk_bf16_f32 v139, v226, v227
    v_mfma_f32_32x32x16_bf16 v[64:79], a[124:127], a[92:95], v[64:79]
    ds_read_b128 a[104:107], v18 offset:24576
    buffer_load_dwordx4 v36, s[12:15], s53 offen offset:1024 lds
    v_exp_f32 v225, v89
    v_add_f32 v228, v228, v224
    s_waitcnt lgkmcnt(11)
    v_mfma_f32_32x32x16_bf16 v[160:175], a[224:227], v[144:147], v[160:175]
    ds_read_b128 a[108:111], v19 offset:24576
    ds_read_b128 a[112:115], v20 offset:24576
    v_exp_f32 v226, v90
    v_add_f32 v228, v228, v225
    v_cvt_pk_bf16_f32 v140, v224, v225
    v_mfma_f32_32x32x16_bf16 v[176:191], a[228:231], v[144:147], v[176:191]
    ds_read_b128 a[116:119], v21 offset:24576
    buffer_load_dwordx4 v36, s[12:15], s53 offen offset:2048 lds
    v_exp_f32 v227, v91
    v_add_f32 v228, v228, v226
    v_mfma_f32_32x32x16_bf16 v[192:207], a[232:235], v[144:147], v[192:207]
    ds_read_b128 a[120:123], v22 offset:24576
    ds_read_b128 a[124:127], v23 offset:24576
    v_exp_f32 v224, v92
    v_add_f32 v228, v228, v227
    v_cvt_pk_bf16_f32 v141, v226, v227
    s_waitcnt lgkmcnt(8)
    v_mfma_f32_32x32x16_bf16 v[208:223], a[236:239], v[144:147], v[208:223]
    ds_read_b64_tr_b16 a[224:225], v28 offset:16384
    buffer_load_dwordx4 v36, s[12:15], s53 offen offset:3072 lds
    v_exp_f32 v225, v93
    v_add_f32 v228, v228, v224
    v_mfma_f32_32x32x16_bf16 v[160:175], a[240:243], v[148:151], v[160:175]
    ds_read_b64_tr_b16 a[226:227], v28 offset:18432
    ds_read_b64_tr_b16 a[228:229], v29 offset:16384
    v_exp_f32 v226, v94
    v_add_f32 v228, v228, v225
    v_cvt_pk_bf16_f32 v142, v224, v225
    s_add_u32 m0, s40, 0
    v_mfma_f32_32x32x16_bf16 v[176:191], a[244:247], v[148:151], v[176:191]
    ds_read_b64_tr_b16 a[230:231], v29 offset:18432
    buffer_load_dwordx4 v32, s[8:11], s58 offen offset:0 lds
    v_exp_f32 v227, v95
    v_add_f32 v228, v228, v226
    v_mfma_f32_32x32x16_bf16 v[192:207], a[248:251], v[148:151], v[192:207]
    ds_read_b64_tr_b16 a[232:233], v30 offset:16384
    ds_read_b64_tr_b16 a[234:235], v30 offset:18432
    v_exp_f32 v224, v64
    v_add_f32 v228, v228, v227
    v_cvt_pk_bf16_f32 v143, v226, v227
    v_mfma_f32_32x32x16_bf16 v[208:223], a[252:255], v[148:151], v[208:223]
    ds_read_b64_tr_b16 a[236:237], v31 offset:16384
    buffer_load_dwordx4 v33, s[8:11], s58 offen offset:1024 lds
    v_cmp_nge_f32 vcc, s44, v228
    v_exp_f32 v225, v65
    s_cbranch_vccnz K_rare_5
K_back_5:
    s_waitcnt lgkmcnt(7)
    v_mfma_f32_32x32x16_bf16 v[80:95], a[96:99], a[64:67], v[96:111]
    ds_read_b64_tr_b16 a[238:239], v31 offset:18432
    ds_read_b64_tr_b16 a[240:241], v28 offset:20480
    v_exp_f32 v226, v66
    v_add_f32 v45, v45, v228
    v_add_f32 v228, v224, v225
    v_cvt_pk_bf16_f32 v144, v224, v225
    v_mfma_f32_32x32x16_bf16 v[80:95], a[100:103], a[68:71], v[80:95]
    ds_read_b64_tr_b16 a[242:243], v28 offset:22528
    buffer_load_dwordx4 v34, s[8:11], s58 offen offset:2048 lds
    v_exp_f32 v227, v67
    v_add_f32 v228, v228, v226
    v_mfma_f32_32x32x16_bf16 v[80:95], a[104:107], a[72:75], v[80:95]
    ds_read_b64_tr_b16 a[244:245], v29 offset:20480
    ds_read_b64_tr_b16 a[246:247], v29 offset:22528
    v_exp_f32 v224, v68
    v_add_f32 v228, v228, v227
    v_cvt_pk_bf16_f32 v145, v226, v227
    v_mfma_f32_32x32x16_bf16 v[80:95], a[108:111], a[76:79], v[80:95]
    ds_read_b64_tr_b16 a[248:249], v30 offset:20480
    buffer_load_dwordx4 v35, s[8:11], s58 offen offset:3072 lds
    v_exp_f32 v225, v69
    v_add_f32 v228, v228, v224
    v_mfma_f32_32x32x16_bf16 v[80:95], a[112:115], a[80:83], v[80:95]
    ds_read_b64_tr_b16 a[250:251], v30 offset:22528
    ds_read_b64_tr_b16 a[252:253], v31 offset:20480
    v_exp_f32 v226, v70
    v_add_f32 v228, v228, v225
    v_cvt_pk_bf16_f32 v146, v224, v225
    s_add_u32 m0, s40, 4096
    v_mfma_f32_32x32x16_bf16 v[80:95], a[116:119], a[84:87], v[80:95]
    ds_read_b64_tr_b16 a[254:255], v31 offset:22528
    buffer_load_dwordx4 v32, s[8:11], s59 offen offset:0 lds
    v_exp_f32 v227, v71
    v_add_f32 v228, v228, v226
    s_waitcnt vmcnt(13)
    v_mfma_f32_32x32x16_bf16 v[80:95], a[120:123], a[88:91], v[80:95]
    ds_read_b128 a[96:99], v8 offset:32768
    ds_read_b128 a[100:103], v9 offset:32768
    v_exp_f32 v224, v72
    v_add_f32 v228, v228, v227
    v_cvt_pk_bf16_f32 v147, v226, v227
    v_mfma_f32_32x32x16_bf16 v[80:95], a[124:127], a[92:95], v[80:95]
    ds_read_b128 a[104:107], v10 offset:32768
    buffer_load_dwordx4 v33, s[8:11], s59 offen offset:1024 lds
    v_exp_f32 v225, v73
    v_add_f32 v228, v228, v224
    s_waitcnt lgkmcnt(11)
    v_mfma_f32_32x32x16_bf16 v[160:175], a[224:227], v[152:155], v[160:175]
    ds_read_b128 a[108:111], v11 offset:32768
    ds_read_b128 a[112:115], v12 offset:32768
    v_exp_f32 v226, v74
    v_add_f32 v228, v228, v225
    v_cvt_pk_bf16_f32 v148, v224, v225
    v_mfma_f32_32x32x16_bf16 v[176:191], a[228:231], v[152:155], v[176:191]
    ds_read_b128 a[116:119], v13 offset:32768
    buffer_load_dwordx4 v34, s[8:11], s59 offen offset:2048 lds
    v_exp_f32 v227, v75
    v_add_f32 v228, v228, v226
    v_mfma_f32_32x32x16_bf16 v[192:207], a[232:235], v[152:155], v[192:207]
    ds_read_b128 a[120:123], v14 offset:32768
    ds_read_b128 a[124:127], v15 offset:32768
    v_exp_f32 v224, v76
    v_add_f32 v228, v228, v227
    v_cvt_pk_bf16_f32 v149, v226, v227
    s_waitcnt lgkmcnt(8)
    s_waitcnt vmcnt(7)
    s_barrier
    v_mfma_f32_32x32x16_bf16 v[208:223], a[236:239], v[152:155], v[208:223]
    ds_read_b64_tr_b16 a[224:225], v24 offset:8192
    buffer_load_dwordx4 v35, s[8:11], s59 offen offset:3072 lds
    v_exp_f32 v225, v77
    v_add_f32 v228, v228, v224
    v_mfma_f32_32x32x16_bf16 v[160:175], a[240:243], v[156:159], v[160:175]
    ds_read_b64_tr_b16 a[226:227], v24 offset:10240
    ds_read_b64_tr_b16 a[228:229], v25 offset:8192
    v_exp_f32 v226, v78
    v_add_f32 v228, v228, v225
    v_cvt_pk_bf16_f32 v150, v224, v225
    s_add_u32 m0, s40, 16384
    v_mfma_f32_32x32x16_bf16 v[176:191], a[244:247], v[156:159], v[176:191]
    ds_read_b64_tr_b16 a[230:231], v25 offset:10240
    buffer_load_dwordx4 v36, s[12:15], s54 offen offset:0 lds
    v_exp_f32 v227, v79
    v_add_f32 v228, v228, v226
    v_mfma_f32_32x32x16_bf16 v[192:207], a[248:251], v[156:159], v[192:207]
    ds_read_b64_tr_b16 a[232:233], v26 offset:8192
    ds_read_b64_tr_b16 a[234:235], v26 offset:10240
    v_exp_f32 v224, v80
    v_add_f32 v228, v228, v227
    v_cvt_pk_bf16_f32 v151, v226, v227
    v_mfma_f32_32x32x16_bf16 v[208:223], a[252:255], v[156:159], v[208:223]
    ds_read_b64_tr_b16 a[236:237], v27 offset:8192
    buffer_load_dwordx4 v36, s[12:15], s54 offen offset:1024 lds
    v_cmp_nge_f32 vcc, s44, v228
    v_exp_f32 v225, v81
    s_cbranch_vccnz K_rare_6
K_back_6:
    s_waitcnt lgkmcnt(7)
    v_mfma_f32_32x32x16_bf16 v[64:79], a[96:99], a[64:67], v[96:111]
    ds_read_b64_tr_b16 a[238:239], v27 offset:10240
    ds_read_b64_tr_b16 a[240:241], v24 offset:12288
    v_exp_f32 v226, v82
    v_add_f32 v45, v45, v228
    v_add_f32 v228, v224, v225
    v_cvt_pk_bf16_f32 v152, v224, v225
    v_mfma_f32_32x32x16_bf16 v[64:79], a[100:103], a[68:71], v[64:79]
    ds_read_b64_tr_b16 a[242:243], v24 offset:14336
    buffer_load_dwordx4 v36, s[12:15], s54 offen offset:2048 lds
    v_exp_f32 v227, v83
    v_add_f32 v228, v228, v226
    v_mfma_f32_32x32x16_bf16 v[64:79], a[104:107], a[72:75], v[64:79]
    ds_read_b64_tr_b16 a[244:245], v25 offset:12288
    ds_read_b64_tr_b16 a[246:247], v25 offset:14336
    v_exp_f32 v224, v84
    v_add_f32 v228, v228, v227
    v_cvt_pk_bf16_f32 v153, v226, v227
    v_mfma_f32_32x32x16_bf16 v[64:79], a[108:111], a[76:79], v[64:79]
    ds_read_b64_tr_b16 a[248:249], v26 offset:12288
    buffer_load_dwordx4 v36, s[12:15], s54 offen offset:3072 lds
    v_exp_f32 v225, v85
    v_add_f32 v228, v228, v224
    v_mfma_f32_32x32x16_bf16 v[64:79], a[112:115], a[80:83], v[64:79]
    ds_read_b64_tr_b16 a[250:251], v26 offset:14336
    ds_read_b64_tr_b16 a[252:253], v27 offset:12288
    v_exp_f32 v226, v86
    v_add_f32 v228, v228, v225
    v_cvt_pk_bf16_f32 v154, v224, v225
    s_add_u32 m0, s40, 20480
    v_mfma_f32_32x32x16_bf16 v[64:79], a[116:119], a[84:87], v[64:79]
    ds_read_b64_tr_b16 a[254:255], v27 offset:14336
    buffer_load_dwordx4 v36, s[12:15], s55 offen offset:0 lds
    v_exp_f32 v227, v87
    v_add_f32 v228, v228, v226
    v_mfma_f32_32x32x16_bf16 v[64:79], a[120:123], a[88:91], v[64:79]
    ds_read_b128 a[96:99], v16 offset:32768
    ds_read_b128 a[100:103], v17 offset:32768
    v_exp_f32 v224, v88
    v_add_f32 v228, v228, v227
    v_cvt_pk_bf16_f32 v155, v226, v227
    v_mfma_f32_32x32x16_bf16 v[64:79], a[124:127], a[92:95], v[64:79]
    ds_read_b128 a[104:107], v18 offset:32768
    buffer_load_dwordx4 v36, s[12:15], s55 offen offset:1024 lds
    v_exp_f32 v225, v89
    v_add_f32 v228, v228, v224
    s_waitcnt lgkmcnt(11)
    v_mfma_f32_32x32x16_bf16 v[160:175], a[224:227], v[128:131], v[160:175]
    ds_read_b128 a[108:111], v19 offset:32768
    ds_read_b128 a[112:115], v20 offset:32768
    v_exp_f32 v226, v90
    v_add_f32 v228, v228, v225
    v_cvt_pk_bf16_f32 v156, v224, v225
    v_mfma_f32_32x32x16_bf16 v[176:191], a[228:231], v[128:131], v[176:191]
    ds_read_b128 a[116:119], v21 offset:32768
    buffer_load_dwordx4 v36, s[12:15], s55 offen offset:2048 lds
    v_exp_f32 v227, v91
    v_add_f32 v228, v228, v226
    v_mfma_f32_32x32x16_bf16 v[192:207], a[232:235], v[128:131], v[192:207]
    ds_read_b128 a[120:123], v22 offset:32768
    ds_read_b128 a[124:127], v23 offset:32768
    v_exp_f32 v224, v92
    v_add_f32 v228, v228, v227
    v_cvt_pk_bf16_f32 v157, v226, v227
    s_waitcnt lgkmcnt(8)
    v_mfma_f32_32x32x16_bf16 v[208:223], a[236:239], v[128:131], v[208:223]
    ds_read_b64_tr_b16 a[224:225], v28 offset:8192
    buffer_load_dwordx4 v36, s[12:15], s55 offen offset:3072 lds
    v_exp_f32 v225, v93
    v_add_f32 v228, v228, v224
    v_mfma_f32_32x32x16_bf16 v[160:175], a[240:243], v[132:135], v[160:175]
    ds_read_b64_tr_b16 a[226:227], v28 offset:10240
    ds_read_b64_tr_b16 a[228:229], v29 offset:8192
    v_exp_f32 v226, v94
    v_add_f32 v228, v228, v225
    v_cvt_pk_bf16_f32 v158, v224, v225
    s_add_u32 m0, s40, 24576
    v_mfma_f32_32x32x16_bf16 v[176:191], a[244:247], v[132:135], v[176:191]
    ds_read_b64_tr_b16 a[230:231], v29 offset:10240
    buffer_load_dwordx4 v32, s[8:11], s60 offen offset:0 lds
    v_exp_f32 v227, v95
    v_add_f32 v228, v228, v226
    v_mfma_f32_32x32x16_bf16 v[192:207], a[248:251], v[132:135], v[192:207]
    ds_read_b64_tr_b16 a[232:233], v30 offset:8192
    ds_read_b64_tr_b16 a[234:235], v30 offset:10240
    v_exp_f32 v224, v64
    v_add_f32 v228, v228, v227
    v_cvt_pk_bf16_f32 v159, v226, v227
    v_mfma_f32_32x32x16_bf16 v[208:223], a[252:255], v[132:135], v[208:223]
    ds_read_b64_tr_b16 a[236:237], v31 offset:8192
    buffer_load_dwordx4 v33, s[8:11], s60 offen offset:1024 lds
    v_cmp_nge_f32 vcc, s44, v228
    v_exp_f32 v225, v65
    s_cbranch_vccnz K_rare_7
K_back_7:
    s_waitcnt lgkmcnt(7)
    v_mfma_f32_32x32x16_bf16 v[80:95], a[96:99], a[64:67], v[96:111]
    ds_read_b64_tr_b16 a[238:239], v31 offset:10240
    ds_read_b64_tr_b16 a[240:241], v28 offset:12288
    v_exp_f32 v226, v66
    v_add_f32 v45, v45, v228
    v_add_f32 v228, v224, v225
    v_cvt_pk_bf16_f32 v128, v224, v225
    v_mfma_f32_32x32x16_bf16 v[80:95], a[100:103], a[68:71], v[80:95]
    ds_read_b64_tr_b16 a[242:243], v28 offset:14336
    buffer_load_dwordx4 v34, s[8:11], s60 offen offset:2048 lds
    v_exp_f32 v227, v67
    v_add_f32 v228, v228, v226
    v_mfma_f32_32x32x16_bf16 v[80:95], a[104:107], a[72:75], v[80:95]
    ds_read_b64_tr_b16 a[244:245], v29 offset:12288
    ds_read_b64_tr_b16 a[246:247], v29 offset:14336
    v_exp_f32 v224, v68
    v_add_f32 v228, v228, v227
    v_cvt_pk_bf16_f32 v129, v226, v227
    v_mfma_f32_32x32x16_bf16 v[80:95], a[108:111], a[76:79], v[80:95]
    ds_read_b64_tr_b16 a[248:249], v30 offset:12288
    buffer_load_dwordx4 v35, s[8:11], s60 offen offset:3072 lds
    v_exp_f32 v225, v69
    v_add_f32 v228, v228, v224
    v_mfma_f32_32x32x16_bf16 v[80:95], a[112:115], a[80:83], v[80:95]
    ds_read_b64_tr_b16 a[250:251], v30 offset:14336
    ds_read_b64_tr_b16 a[252:253], v31 offset:12288
    v_exp_f32 v226, v70
    v_add_f32 v228, v228, v225
    v_cvt_pk_bf16_f32 v130, v224, v225
    s_add_u32 m0, s40, 28672
    v_mfma_f32_32x32x16_bf16 v[80:95], a[116:119], a[84:87], v[80:95]
    ds_read_b64_tr_b16 a[254:255], v31 offset:14336
    buffer_load_dwordx4 v32, s[8:11], s61 offen offset:0 lds
    v_exp_f32 v227, v71
    v_add_f32 v228, v228, v226
    s_waitcnt vmcnt(13)
    v_mfma_f32_32x32x16_bf16 v[80:95], a[120:123], a[88:91], v[80:95]
    ds_read_b128 a[96:99], v8 offset:0
    ds_read_b128 a[100:103], v9 offset:0
    v_exp_f32 v224, v72
    v_add_f32 v228, v228, v227
    v_cvt_pk_bf16_f32 v131, v226, v227
    v_mfma_f32_32x32x16_bf16 v[80:95], a[124:127], a[92:95], v[80:95]
    ds_read_b128 a[104:107], v10 offset:0
    buffer_load_dwordx4 v33, s[8:11], s61 offen offset:1024 lds
    v_exp_f32 v225, v73
    v_add_f32 v228, v228, v224
    s_waitcnt lgkmcnt(11)
    v_mfma_f32_32x32x16_bf16 v[160:175], a[224:227], v[136:139], v[160:175]
    ds_read_b128 a[108:111], v11 offset:0
    ds_read_b128 a[112:115], v12 offset:0
    v_exp_f32 v226, v74
    v_add_f32 v228, v228, v225
    v_cvt_pk_bf16_f32 v132, v224, v225
    v_mfma_f32_32x32x16_bf16 v[176:191], a[228:231], v[136:139], v[176:191]
    ds_read_b128 a[116:119], v13 offset:0
    buffer_load_dwordx4 v34, s[8:11], s61 offen offset:2048 lds
    v_exp_f32 v227, v75
    v_add_f32 v228, v228, v226
    v_mfma_f32_32x32x16_bf16 v[192:207], a[232:235], v[136:139], v[192:207]
    ds_read_b128 a[120:123], v14 offset:0
    ds_read_b128 a[124:127], v15 offset:0
    v_exp_f32 v224, v76
    v_add_f32 v228, v228, v227
    v_cvt_pk_bf16_f32 v133, v226, v227
    s_waitcnt lgkmcnt(8)
    s_waitcnt vmcnt(7)
    s_barrier
    v_mfma_f32_32x32x16_bf16 v[208:223], a[236:239], v[136:139], v[208:223]
    ds_read_b64_tr_b16 a[224:225], v24 offset:16384
    buffer_load_dwordx4 v35, s[8:11], s61 offen offset:3072 lds
    v_exp_f32 v225, v77
    v_add_f32 v228, v228, v224
    v_mfma_f32_32x32x16_bf16 v[160:175], a[240:243], v[140:143], v[160:175]
    ds_read_b64_tr_b16 a[226:227], v24 offset:18432
    ds_read_b64_tr_b16 a[228:229], v25 offset:16384
    v_exp_f32 v226, v78
    v_add_f32 v228, v228, v225
    v_cvt_pk_bf16_f32 v134, v224, v225
    s_add_u32 m0, s40, 8192
    v_mfma_f32_32x32x16_bf16 v[176:191], a[244:247], v[140:143], v[176:191]
    ds_read_b64_tr_b16 a[230:231], v25 offset:18432
    buffer_load_dwordx4 v36, s[12:15], s56 offen offset:0 lds
    v_exp_f32 v227, v79
    v_add_f32 v228, v228, v226
    v_mfma_f32_32x32x16_bf16 v[192:207], a[248:251], v[140:143], v[192:207]
    ds_read_b64_tr_b16 a[232:233], v26 offset:16384
    ds_read_b64_tr_b16 a[234:235], v26 offset:18432
    v_exp_f32 v224, v80
    v_add_f32 v228, v228, v227
    v_cvt_pk_bf16_f32 v135, v226, v227
    v_mfma_f32_32x32x16_bf16 v[208:223], a[252:255], v[140:143], v[208:223]
    ds_read_b64_tr_b16 a[236:237], v27 offset:16384
    buffer_load_dwordx4 v36, s[12:15], s56 offen offset:1024 lds
    v_cmp_nge_f32 vcc, s44, v228
    v_exp_f32 v225, v81
    s_cbranch_vccnz K_rare_8
K_back_8:
    s_waitcnt lgkmcnt(7)
    v_mfma_f32_32x32x16_bf16 v[64:79], a[96:99], a[64:67], v[96:111]
    ds_read_b64_tr_b16 a[238:239], v27 offset:18432
    ds_read_b64_tr_b16 a[240:241], v24 offset:20480
    v_exp_f32 v226, v82
    v_add_f32 v45, v45, v228
    v_add_f32 v228, v224, v225
    v_cvt_pk_bf16_f32 v136, v224, v225
    v_mfma_f32_32x32x16_bf16 v[64:79], a[100:103], a[68:71], v[64:79]
    ds_read_b64_tr_b16 a[242:243], v24 offset:22528
    buffer_load_dwordx4 v36, s[12:15], s56 offen offset:2048 lds
    v_exp_f32 v227, v83
    v_add_f32 v228, v228, v226
    v_mfma_f32_32x32x16_bf16 v[64:79], a[104:107], a[72:75], v[64:79]
    ds_read_b64_tr_b16 a[244:245], v25 offset:20480
    ds_read_b64_tr_b16 a[246:247], v25 offset:22528
    v_exp_f32 v224, v84
    v_add_f32 v228, v228, v227
    v_cvt_pk_bf16_f32 v137, v226, v227
    v_mfma_f32_32x32x16_bf16 v[64:79], a[108:111], a[76:79], v[64:79]
    ds_read_b64_tr_b16 a[248:249], v26 offset:20480
    buffer_load_dwordx4 v36, s[12:15], s56 offen offset:3072 lds
    v_exp_f32 v225, v85
    v_add_f32 v228, v228, v224
    v_mfma_f32_32x32x16_bf16 v[64:79], a[112:115], a[80:83], v[64:79]
    ds_read_b64_tr_b16 a[250:251], v26 offset:22528
    ds_read_b64_tr_b16 a[252:253], v27 offset:20480
    v_exp_f32 v226, v86
    v_add_f32 v228, v228, v225
    v_cvt_pk_bf16_f32 v138, v224, v225
    s_add_u32 m0, s40, 12288
    v_mfma_f32_32x32x16_bf16 v[64:79], a[116:119], a[84:87], v[64:79]
    ds_read_b64_tr_b16 a[254:255], v27 offset:22528
    buffer_load_dwordx4 v36, s[12:15], s57 offen offset:0 lds
    v_exp_f32 v227, v87
    v_add_f32 v228, v228, v226
    v_mfma_f32_32x32x16_bf16 v[64:79], a[120:123], a[88:91], v[64:79]
    ds_read_b128 a[96:99], v16 offset:0
    ds_read_b128 a[100:103], v17 offset:0
    v_exp_f32 v224, v88
    v_add_f32 v228, v228, v227
    v_cvt_pk_bf16_f32 v139, v226, v227
    v_mfma_f32_32x32x16_bf16 v[64:79], a[124:127], a[92:95], v[64:79]
    ds_read_b128 a[104:107], v18 offset:0
    buffer_load_dwordx4 v36, s[12:15], s57 offen offset:1024 lds
    v_exp_f32 v225, v89
    v_add_f32 v228, v228, v224
    s_waitcnt lgkmcnt(11)
    v_mfma_f32_32x32x16_bf16 v[160:175], a[224:227], v[144:147], v[160:175]
    ds_read_b128 a[108:111], v19 offset:0
    ds_read_b128 a[112:115], v20 offset:0
    v_exp_f32 v226, v90
    v_add_f32 v228, v228, v225
    v_cvt_pk_bf16_f32 v140, v224, v225
    v_mfma_f32_32x32x16_bf16 v[176:191], a[228:231], v[144:147], v[176:191]
    ds_read_b128 a[116:119], v21 offset:0
    buffer_load_dwordx4 v36, s[12:15], s57 offen offset:2048 lds
    v_exp_f32 v227, v91
    v_add_f32 v228, v228, v226
    v_mfma_f32_32x32x16_bf16 v[192:207], a[232:235], v[144:147], v[192:207]
    ds_read_b128 a[120:123], v22 offset:0
    ds_read_b128 a[124:127], v23 offset:0
    v_exp_f32 v224, v92
    v_add_f32 v228, v228, v227
    v_cvt_pk_bf16_f32 v141, v226, v227
    s_waitcnt lgkmcnt(8)
    v_mfma_f32_32x32x16_bf16 v[208:223], a[236:239], v[144:147], v[208:223]
    ds_read_b64_tr_b16 a[224:225], v28 offset:16384
    buffer_load_dwordx4 v36, s[12:15], s57 offen offset:3072 lds
    v_exp_f32 v225, v93
    v_add_f32 v228, v228, v224
    v_mfma_f32_32x32x16_bf16 v[160:175], a[240:243], v[148:151], v[160:175]
    ds_read_b64_tr_b16 a[226:227], v28 offset:18432
    ds_read_b64_tr_b16 a[228:229], v29 offset:16384
    v_exp_f32 v226, v94
    v_add_f32 v228, v228, v225
    v_cvt_pk_bf16_f32 v142, v224, v225
    s_add_u32 m0, s40, 32768
    v_mfma_f32_32x32x16_bf16 v[176:191], a[244:247], v[148:151], v[176:191]
    ds_read_b64_tr_b16 a[230:231], v29 offset:18432
    buffer_load_dwordx4 v32, s[8:11], s62 offen offset:0 lds
    v_exp_f32 v227, v95
    v_add_f32 v228, v228, v226
    v_mfma_f32_32x32x16_bf16 v[192:207], a[248:251], v[148:151], v[192:207]
    ds_read_b64_tr_b16 a[232:233], v30 offset:16384
    ds_read_b64_tr_b16 a[234:235], v30 offset:18432
    v_exp_f32 v224, v64
    v_add_f32 v228, v228, v227
    v_cvt_pk_bf16_f32 v143, v226, v227
    v_mfma_f32_32x32x16_bf16 v[208:223], a[252:255], v[148:151], v[208:223]
    ds_read_b64_tr_b16 a[236:237], v31 offset:16384
    buffer_load_dwordx4 v33, s[8:11], s62 offen offset:1024 lds
    v_cmp_nge_f32 vcc, s44, v228
    v_exp_f32 v225, v65
    s_cbranch_vccnz K_rare_9
K_back_9:
    s_waitcnt lgkmcnt(7)
    v_mfma_f32_32x32x16_bf16 v[80:95], a[96:99], a[64:67], v[96:111]
    ds_read_b64_tr_b16 a[238:239], v31 offset:18432
    ds_read_b64_tr_b16 a[240:241], v28 offset:20480
    v_exp_f32 v226, v66
    v_add_f32 v45, v45, v228
    v_add_f32 v228, v224, v225
    v_cvt_pk_bf16_f32 v144, v224, v225
    v_mfma_f32_32x32x16_bf16 v[80:95], a[100:103], a[68:71], v[80:95]
    ds_read_b64_tr_b16 a[242:243], v28 offset:22528
    buffer_load_dwordx4 v34, s[8:11], s62 offen offset:2048 lds
    v_exp_f32 v227, v67
    v_add_f32 v228, v228, v226
    v_mfma_f32_32x32x16_bf16 v[80:95], a[104:107], a[72:75], v[80:95]
    ds_read_b64_tr_b16 a[244:245], v29 offset:20480
    ds_read_b64_tr_b16 a[246:247], v29 offset:22528
    v_exp_f32 v224, v68
    v_add_f32 v228, v228, v227
    v_cvt_pk_bf16_f32 v145, v226, v227
    v_mfma_f32_32x32x16_bf16 v[80:95], a[108:111], a[76:79], v[80:95]
    ds_read_b64_tr_b16 a[248:249], v30 offset:20480
    buffer_load_dwordx4 v35, s[8:11], s62 offen offset:3072 lds
    v_exp_f32 v225, v69
    v_add_f32 v228, v228, v224
    v_mfma_f32_32x32x16_bf16 v[80:95], a[112:115], a[80:83], v[80:95]
    ds_read_b64_tr_b16 a[250:251], v30 offset:22528
    ds_read_b64_tr_b16 a[252:253], v31 offset:20480
    v_exp_f32 v226, v70
    v_add_f32 v228, v228, v225
    v_cvt_pk_bf16_f32 v146, v224, v225
    s_add_u32 m0, s40, 36864
    v_mfma_f32_32x32x16_bf16 v[80:95], a[116:119], a[84:87], v[80:95]
    ds_read_b64_tr_b16 a[254:255], v31 offset:22528
    buffer_load_dwordx4 v32, s[8:11], s63 offen offset:0 lds
    v_exp_f32 v227, v71
    v_add_f32 v228, v228, v226
    s_waitcnt vmcnt(13)
    v_mfma_f32_32x32x16_bf16 v[80:95], a[120:123], a[88:91], v[80:95]
    ds_read_b128 a[96:99], v8 offset:24576
    ds_read_b128 a[100:103], v9 offset:24576
    v_exp_f32 v224, v72
    v_add_f32 v228, v228, v227
    v_cvt_pk_bf16_f32 v147, v226, v227
    v_mfma_f32_32x32x16_bf16 v[80:95], a[124:127], a[92:95], v[80:95]
    ds_read_b128 a[104:107], v10 offset:24576
    buffer_load_dwordx4 v33, s[8:11], s63 offen offset:1024 lds
    v_exp_f32 v225, v73
    v_add_f32 v228, v228, v224
    s_waitcnt lgkmcnt(11)
    v_mfma_f32_32x32x16_bf16 v[160:175], a[224:227], v[152:155], v[160:175]
    ds_read_b128 a[108:111], v11 offset:24576
    ds_read_b128 a[112:115], v12 offset:24576
    v_exp_f32 v226, v74
    v_add_f32 v228, v228, v225
    v_cvt_pk_bf16_f32 v148, v224, v225
    v_mfma_f32_32x32x16_bf16 v[176:191], a[228:231], v[152:155], v[176:191]
    ds_read_b128 a[116:119], v13 offset:24576
    buffer_load_dwordx4 v34, s[8:11], s63 offen offset:2048 lds
    v_exp_f32 v227, v75
    v_add_f32 v228, v228, v226
    v_mfma_f32_32x32x16_bf16 v[192:207], a[232:235], v[152:155], v[192:207]
    ds_read_b128 a[120:123], v14 offset:24576
    ds_read_b128 a[124:127], v15 offset:24576
    v_exp_f32 v224, v76
    v_add_f32 v228, v228, v227
    v_cvt_pk_bf16_f32 v149, v226, v227
    s_waitcnt lgkmcnt(8)
    s_waitcnt vmcnt(7)
    s_barrier
    v_mfma_f32_32x32x16_bf16 v[208:223], a[236:239], v[152:155], v[208:223]
    ds_read_b64_tr_b16 a[224:225], v24 offset:8192
    buffer_load_dwordx4 v35, s[8:11], s63 offen offset:3072 lds
    v_exp_f32 v225, v77
    v_add_f32 v228, v228, v224
    v_mfma_f32_32x32x16_bf16 v[160:175], a[240:243], v[156:159], v[160:175]
    ds_read_b64_tr_b16 a[226:227], v24 offset:10240
    ds_read_b64_tr_b16 a[228:229], v25 offset:8192
    v_exp_f32 v226, v78
    v_add_f32 v228, v228, v225
    v_cvt_pk_bf16_f32 v150, v224, v225
    s_add_u32 m0, s40, 16384
    v_mfma_f32_32x32x16_bf16 v[176:191], a[244:247], v[156:159], v[176:191]
    ds_read_b64_tr_b16 a[230:231], v25 offset:10240
    buffer_load_dwordx4 v36, s[12:15], s58 offen offset:0 lds
    v_exp_f32 v227, v79
    v_add_f32 v228, v228, v226
    v_mfma_f32_32x32x16_bf16 v[192:207], a[248:251], v[156:159], v[192:207]
    ds_read_b64_tr_b16 a[232:233], v26 offset:8192
    ds_read_b64_tr_b16 a[234:235], v26 offset:10240
    v_exp_f32 v224, v80
    v_add_f32 v228, v228, v227
    v_cvt_pk_bf16_f32 v151, v226, v227
    v_mfma_f32_32x32x16_bf16 v[208:223], a[252:255], v[156:159], v[208:223]
    ds_read_b64_tr_b16 a[236:237], v27 offset:8192
    buffer_load_dwordx4 v36, s[12:15], s58 offen offset:1024 lds
    v_cmp_nge_f32 vcc, s44, v228
    v_exp_f32 v225, v81
    s_cbranch_vccnz K_rare_10
K_back_10:
    s_waitcnt lgkmcnt(7)
    v_mfma_f32_32x32x16_bf16 v[64:79], a[96:99], a[64:67], v[96:111]
    ds_read_b64_tr_b16 a[238:239], v27 offset:10240
    ds_read_b64_tr_b16 a[240:241], v24 offset:12288
    v_exp_f32 v226, v82
    v_add_f32 v45, v45, v228
    v_add_f32 v228, v224, v225
    v_cvt_pk_bf16_f32 v152, v224, v225
    v_mfma_f32_32x32x16_bf16 v[64:79], a[100:103], a[68:71], v[64:79]
    ds_read_b64_tr_b16 a[242:243], v24 offset:14336
    buffer_load_dwordx4 v36, s[12:15], s58 offen offset:2048 lds
    v_exp_f32 v227, v83
    v_add_f32 v228, v228, v226
    s_lshl_b32 s96, s42, 8
    v_mfma_f32_32x32x16_bf16 v[64:79], a[104:107], a[72:75], v[64:79]
    ds_read_b64_tr_b16 a[244:245], v25 offset:12288
    ds_read_b64_tr_b16 a[246:247], v25 offset:14336
    v_exp_f32 v224, v84
    v_add_f32 v228, v228, v227
    v_cvt_pk_bf16_f32 v153, v226, v227
    s_lshl_b32 s97, s36, 6
    v_mfma_f32_32x32x16_bf16 v[64:79], a[108:111], a[76:79], v[64:79]
    ds_read_b64_tr_b16 a[248:249], v26 offset:12288
    buffer_load_dwordx4 v36, s[12:15], s58 offen offset:3072 lds
    v_exp_f32 v225, v85
    v_add_f32 v228, v228, v224
    s_add_u32 s97, s96, s97
    v_mfma_f32_32x32x16_bf16 v[64:79], a[112:115], a[80:83], v[64:79]
    ds_read_b64_tr_b16 a[250:251], v26 offset:14336
    ds_read_b64_tr_b16 a[252:253], v27 offset:12288
    v_exp_f32 v226, v86
    v_add_f32 v228, v228, v225
    v_cvt_pk_bf16_f32 v154, v224, v225
    s_xor_b32 s48, s43, 0
    s_add_u32 m0, s40, 20480
    v_mfma_f32_32x32x16_bf16 v[64:79], a[116:119], a[84:87], v[64:79]
    ds_read_b64_tr_b16 a[254:255], v27 offset:14336
    buffer_load_dwordx4 v36, s[12:15], s59 offen offset:0 lds
    v_exp_f32 v227, v87
    v_add_f32 v228, v228, v226
    s_lshl_b32 s48, s48, 17
    v_mfma_f32_32x32x16_bf16 v[64:79], a[120:123], a[88:91], v[64:79]
    ds_read_b128 a[96:99], v16 offset:24576
    ds_read_b128 a[100:103], v17 offset:24576
    v_exp_f32 v224, v88
    v_add_f32 v228, v228, v227
    v_cvt_pk_bf16_f32 v155, v226, v227
    s_add_u32 s48, s48, s97
    v_mfma_f32_32x32x16_bf16 v[64:79], a[124:127], a[92:95], v[64:79]
    ds_read_b128 a[104:107], v18 offset:24576
    buffer_load_dwordx4 v36, s[12:15], s59 offen offset:1024 lds
    v_exp_f32 v225, v89
    v_add_f32 v228, v228, v224
    s_add_u32 s49, s48, 65536
    s_waitcnt lgkmcnt(11)
    v_mfma_f32_32x32x16_bf16 v[160:175], a[224:227], v[128:131], v[160:175]
    ds_read_b128 a[108:111], v19 offset:24576
    ds_read_b128 a[112:115], v20 offset:24576
    v_exp_f32 v226, v90
    v_add_f32 v228, v228, v225
    v_cvt_pk_bf16_f32 v156, v224, v225
    s_xor_b32 s50, s43, 1
    v_mfma_f32_32x32x16_bf16 v[176:191], a[228:231], v[128:131], v[176:191]
    ds_read_b128 a[116:119], v21 offset:24576
    buffer_load_dwordx4 v36, s[12:15], s59 offen offset:2048 lds
    v_exp_f32 v227, v91
    v_add_f32 v228, v228, v226
    s_lshl_b32 s50, s50, 17
    v_mfma_f32_32x32x16_bf16 v[192:207], a[232:235], v[128:131], v[192:207]
    ds_read_b128 a[120:123], v22 offset:24576
    ds_read_b128 a[124:127], v23 offset:24576
    v_exp_f32 v224, v92
    v_add_f32 v228, v228, v227
    v_cvt_pk_bf16_f32 v157, v226, v227
    s_add_u32 s50, s50, s97
    s_waitcnt lgkmcnt(8)
    v_mfma_f32_32x32x16_bf16 v[208:223], a[236:239], v[128:131], v[208:223]
    ds_read_b64_tr_b16 a[224:225], v28 offset:8192
    buffer_load_dwordx4 v36, s[12:15], s59 offen offset:3072 lds
    v_exp_f32 v225, v93
    v_add_f32 v228, v228, v224
    s_add_u32 s51, s50, 65536
    v_mfma_f32_32x32x16_bf16 v[160:175], a[240:243], v[132:135], v[160:175]
    ds_read_b64_tr_b16 a[226:227], v28 offset:10240
    ds_read_b64_tr_b16 a[228:229], v29 offset:8192
    v_exp_f32 v226, v94
    v_add_f32 v228, v228, v225
    v_cvt_pk_bf16_f32 v158, v224, v225
    s_add_u32 m0, s40, 0
    v_mfma_f32_32x32x16_bf16 v[176:191], a[244:247], v[132:135], v[176:191]
    ds_read_b64_tr_b16 a[230:231], v29 offset:10240
    buffer_load_dwordx4 v36, s[12:15], s60 offen offset:0 lds
    v_exp_f32 v227, v95
    v_add_f32 v228, v228, v226
    v_mfma_f32_32x32x16_bf16 v[192:207], a[248:251], v[132:135], v[192:207]
    ds_read_b64_tr_b16 a[232:233], v30 offset:8192
    ds_read_b64_tr_b16 a[234:235], v30 offset:10240
    v_exp_f32 v224, v64
    v_add_f32 v228, v228, v227
    v_cvt_pk_bf16_f32 v159, v226, v227
    v_mfma_f32_32x32x16_bf16 v[208:223], a[252:255], v[132:135], v[208:223]
    ds_read_b64_tr_b16 a[236:237], v31 offset:8192
    buffer_load_dwordx4 v36, s[12:15], s60 offen offset:1024 lds
    v_cmp_nge_f32 vcc, s44, v228
    v_exp_f32 v225, v65
    s_cbranch_vccnz K_rare_11
K_back_11:
    s_waitcnt lgkmcnt(7)
    v_mfma_f32_32x32x16_bf16 v[80:95], a[96:99], a[64:67], v[96:111]
    ds_read_b64_tr_b16 a[238:239], v31 offset:10240
    ds_read_b64_tr_b16 a[240:241], v28 offset:12288
    v_exp_f32 v226, v66
    v_add_f32 v45, v45, v228
    v_add_f32 v228, v224, v225
    v_cvt_pk_bf16_f32 v128, v224, v225
    v_mfma_f32_32x32x16_bf16 v[80:95], a[100:103], a[68:71], v[80:95]
    ds_read_b64_tr_b16 a[242:243], v28 offset:14336
    buffer_load_dwordx4 v36, s[12:15], s60 offen offset:2048 lds
    v_exp_f32 v227, v67
    v_add_f32 v228, v228, v226
    s_xor_b32 s52, s43, 2
    v_mfma_f32_32x32x16_bf16 v[80:95], a[104:107], a[72:75], v[80:95]
    ds_read_b64_tr_b16 a[244:245], v29 offset:12288
    ds_read_b64_tr_b16 a[246:247], v29 offset:14336
    v_exp_f32 v224, v68
    v_add_f32 v228, v228, v227
    v_cvt_pk_bf16_f32 v129, v226, v227
    s_lshl_b32 s52, s52, 17
    v_mfma_f32_32x32x16_bf16 v[80:95], a[108:111], a[76:79], v[80:95]
    ds_read_b64_tr_b16 a[248:249], v30 offset:12288
    buffer_load_dwordx4 v36, s[12:15], s60 offen offset:3072 lds
    v_exp_f32 v225, v69
    v_add_f32 v228, v228, v224
    s_add_u32 s52, s52, s97
    v_mfma_f32_32x32x16_bf16 v[80:95], a[112:115], a[80:83], v[80:95]
    ds_read_b64_tr_b16 a[250:251], v30 offset:14336
    ds_read_b64_tr_b16 a[252:253], v31 offset:12288
    v_exp_f32 v226, v70
    v_add_f32 v228, v228, v225
    v_cvt_pk_bf16_f32 v130, v224, v225
    s_add_u32 s53, s52, 65536
    s_add_u32 m0, s40, 4096
    v_mfma_f32_32x32x16_bf16 v[80:95], a[116:119], a[84:87], v[80:95]
    ds_read_b64_tr_b16 a[254:255], v31 offset:14336
    buffer_load_dwordx4 v36, s[12:15], s61 offen offset:0 lds
    v_exp_f32 v227, v71
    v_add_f32 v228, v228, v226
    s_xor_b32 s54, s43, 3
    s_waitcnt vmcnt(13)
    v_mfma_f32_32x32x16_bf16 v[80:95], a[120:123], a[88:91], v[80:95]
    ds_read_b128 a[96:99], v8 offset:32768
    ds_read_b128 a[100:103], v9 offset:32768
    v_exp_f32 v224, v72
    v_add_f32 v228, v228, v227
    v_cvt_pk_bf16_f32 v131, v226, v227
    s_lshl_b32 s54, s54, 17
    v_mfma_f32_32x32x16_bf16 v[80:95], a[124:127], a[92:95], v[80:95]
    ds_read_b128 a[104:107], v10 offset:32768
    buffer_load_dwordx4 v36, s[12:15], s61 offen offset:1024 lds
    v_exp_f32 v225, v73
    v_add_f32 v228, v228, v224
    s_add_u32 s54, s54, s97
    s_waitcnt lgkmcnt(11)
    v_mfma_f32_32x32x16_bf16 v[160:175], a[224:227], v[136:139], v[160:175]
    ds_read_b128 a[108:111], v11 offset:32768
    ds_read_b128 a[112:115], v12 offset:32768
    v_exp_f32 v226, v74
    v_add_f32 v228, v228, v225
    v_cvt_pk_bf16_f32 v132, v224, v225
    s_add_u32 s55, s54, 65536
    v_mfma_f32_32x32x16_bf16 v[176:191], a[228:231], v[136:139], v[176:191]
    ds_read_b128 a[116:119], v13 offset:32768
    buffer_load_dwordx4 v36, s[12:15], s61 offen offset:2048 lds
    v_exp_f32 v227, v75
    v_add_f32 v228, v228, v226
    v_mfma_f32_32x32x16_bf16 v[192:207], a[232:235], v[136:139], v[192:207]
    ds_read_b128 a[120:123], v14 offset:32768
    ds_read_b128 a[124:127], v15 offset:32768
    v_exp_f32 v224, v76
    v_add_f32 v228, v228, v227
    v_cvt_pk_bf16_f32 v133, v226, v227
    s_waitcnt lgkmcnt(8)
    s_waitcnt vmcnt(7)
    s_barrier
    v_mfma_f32_32x32x16_bf16 v[208:223], a[236:239], v[136:139], v[208:223]
    ds_read_b64_tr_b16 a[224:225], v24 offset:16384
    buffer_load_dwordx4 v36, s[12:15], s61 offen offset:3072 lds
    v_exp_f32 v225, v77
    v_add_f32 v228, v228, v224
    v_mfma_f32_32x32x16_bf16 v[160:175], a[240:243], v[140:143], v[160:175]
    ds_read_b64_tr_b16 a[226:227], v24 offset:18432
    ds_read_b64_tr_b16 a[228:229], v25 offset:16384
    v_exp_f32 v226, v78
    v_add_f32 v228, v228, v225
    v_cvt_pk_bf16_f32 v134, v224, v225
    s_add_u32 m0, s40, 8192
    v_mfma_f32_32x32x16_bf16 v[176:191], a[244:247], v[140:143], v[176:191]
    ds_read_b64_tr_b16 a[230:231], v25 offset:18432
    buffer_load_dwordx4 v36, s[12:15], s62 offen offset:0 lds
    v_exp_f32 v227, v79
    v_add_f32 v228, v228, v226
    v_mfma_f32_32x32x16_bf16 v[192:207], a[248:251], v[140:143], v[192:207]
    ds_read_b64_tr_b16 a[232:233], v26 offset:16384
    ds_read_b64_tr_b16 a[234:235], v26 offset:18432
    v_exp_f32 v224, v80
    v_add_f32 v228, v228, v227
    v_cvt_pk_bf16_f32 v135, v226, v227
    v_mfma_f32_32x32x16_bf16 v[208:223], a[252:255], v[140:143], v[208:223]
    ds_read_b64_tr_b16 a[236:237], v27 offset:16384
    buffer_load_dwordx4 v36, s[12:15], s62 offen offset:1024 lds
    v_cmp_nge_f32 vcc, s44, v228
    v_exp_f32 v225, v81
    s_cbranch_vccnz K_rare_12
K_back_12:
    s_waitcnt lgkmcnt(7)
    v_mfma_f32_32x32x16_bf16 v[64:79], a[96:99], a[64:67], v[96:111]
    ds_read_b64_tr_b16 a[238:239], v27 offset:18432
    ds_read_b64_tr_b16 a[240:241], v24 offset:20480
    v_exp_f32 v226, v82
    v_add_f32 v45, v45, v228
    v_add_f32 v228, v224, v225
    v_cvt_pk_bf16_f32 v136, v224, v225
    v_mfma_f32_32x32x16_bf16 v[64:79], a[100:103], a[68:71], v[64:79]
    ds_read_b64_tr_b16 a[242:243], v24 offset:22528
    buffer_load_dwordx4 v36, s[12:15], s62 offen offset:2048 lds
    v_exp_f32 v227, v83
    v_add_f32 v228, v228, v226
    v_mfma_f32_32x32x16_bf16 v[64:79], a[104:107], a[72:75], v[64:79]
    ds_read_b64_tr_b16 a[244:245], v25 offset:20480
    ds_read_b64_tr_b16 a[246:247], v25 offset:22528
    v_exp_f32 v224, v84
    v_add_f32 v228, v228, v227
    v_cvt_pk_bf16_f32 v137, v226, v227
    v_mfma_f32_32x32x16_bf16 v[64:79], a[108:111], a[76:79], v[64:79]
    ds_read_b64_tr_b16 a[248:249], v26 offset:20480
    buffer_load_dwordx4 v36, s[12:15], s62 offen offset:3072 lds
    v_exp_f32 v225, v85
    v_add_f32 v228, v228, v224
    v_mfma_f32_32x32x16_bf16 v[64:79], a[112:115], a[80:83], v[64:79]
    ds_read_b64_tr_b16 a[250:251], v26 offset:22528
    ds_read_b64_tr_b16 a[252:253], v27 offset:20480
    v_exp_f32 v226, v86
    v_add_f32 v228, v228, v225
    v_cvt_pk_bf16_f32 v138, v224, v225
    s_add_u32 m0, s40, 12288
    v_mfma_f32_32x32x16_bf16 v[64:79], a[116:119], a[84:87], v[64:79]
    ds_read_b64_tr_b16 a[254:255], v27 offset:22528
    buffer_load_dwordx4 v36, s[12:15], s63 offen offset:0 lds
    v_exp_f32 v227, v87
    v_add_f32 v228, v228, v226
    v_mfma_f32_32x32x16_bf16 v[64:79], a[120:123], a[88:91], v[64:79]
    ds_read_b128 a[96:99], v16 offset:32768
    ds_read_b128 a[100:103], v17 offset:32768
    v_exp_f32 v224, v88
    v_add_f32 v228, v228, v227
    v_cvt_pk_bf16_f32 v139, v226, v227
    v_mfma_f32_32x32x16_bf16 v[64:79], a[124:127], a[92:95], v[64:79]
    ds_read_b128 a[104:107], v18 offset:32768
    buffer_load_dwordx4 v36, s[12:15], s63 offen offset:1024 lds
    v_exp_f32 v225, v89
    v_add_f32 v228, v228, v224
    s_waitcnt lgkmcnt(11)
    v_mfma_f32_32x32x16_bf16 v[160:175], a[224:227], v[144:147], v[160:175]
    ds_read_b128 a[108:111], v19 offset:32768
    ds_read_b128 a[112:115], v20 offset:32768
    v_exp_f32 v226, v90
    v_add_f32 v228, v228, v225
    v_cvt_pk_bf16_f32 v140, v224, v225
    v_mfma_f32_32x32x16_bf16 v[176:191], a[228:231], v[144:147], v[176:191]
    ds_read_b128 a[116:119], v21 offset:32768
    buffer_load_dwordx4 v36, s[12:15], s63 offen offset:2048 lds
    v_exp_f32 v227, v91
    v_add_f32 v228, v228, v226
    v_mfma_f32_32x32x16_bf16 v[192:207], a[232:235], v[144:147], v[192:207]
    ds_read_b128 a[120:123], v22 offset:32768
    ds_read_b128 a[124:127], v23 offset:32768
    v_exp_f32 v224, v92
    v_add_f32 v228, v228, v227
    v_cvt_pk_bf16_f32 v141, v226, v227
    s_waitcnt lgkmcnt(8)
    v_mfma_f32_32x32x16_bf16 v[208:223], a[236:239], v[144:147], v[208:223]
    ds_read_b64_tr_b16 a[224:225], v28 offset:16384
    buffer_load_dwordx4 v36, s[12:15], s63 offen offset:3072 lds
    v_exp_f32 v225, v93
    v_add_f32 v228, v228, v224
    v_mfma_f32_32x32x16_bf16 v[160:175], a[240:243], v[148:151], v[160:175]
    ds_read_b64_tr_b16 a[226:227], v28 offset:18432
    ds_read_b64_tr_b16 a[228:229], v29 offset:16384
    v_exp_f32 v226, v94
    v_add_f32 v228, v228, v225
    v_cvt_pk_bf16_f32 v142, v224, v225
    v_mfma_f32_32x32x16_bf16 v[176:191], a[244:247], v[148:151], v[176:191]
    ds_read_b64_tr_b16 a[230:231], v29 offset:18432
    v_exp_f32 v227, v95
    v_add_f32 v228, v228, v226
    v_mfma_f32_32x32x16_bf16 v[192:207], a[248:251], v[148:151], v[192:207]
    ds_read_b64_tr_b16 a[232:233], v30 offset:16384
    ds_read_b64_tr_b16 a[234:235], v30 offset:18432
    v_exp_f32 v224, v64
    v_add_f32 v228, v228, v227
    v_cvt_pk_bf16_f32 v143, v226, v227
    v_mfma_f32_32x32x16_bf16 v[208:223], a[252:255], v[148:151], v[208:223]
    ds_read_b64_tr_b16 a[236:237], v31 offset:16384
    v_cmp_nge_f32 vcc, s44, v228
    v_exp_f32 v225, v65
    s_cbranch_vccnz K_rare_13
K_back_13:
    s_waitcnt lgkmcnt(7)
    v_mfma_f32_32x32x16_bf16 v[80:95], a[96:99], a[64:67], v[96:111]
    ds_read_b64_tr_b16 a[238:239], v31 offset:18432
    ds_read_b64_tr_b16 a[240:241], v28 offset:20480
    v_exp_f32 v226, v66
    v_add_f32 v45, v45, v228
    v_add_f32 v228, v224, v225
    v_cvt_pk_bf16_f32 v144, v224, v225
    v_mfma_f32_32x32x16_bf16 v[80:95], a[100:103], a[68:71], v[80:95]
    ds_read_b64_tr_b16 a[242:243], v28 offset:22528
    buffer_load_dwordx2 v[60:61], v63, s[20:23], s6 offen offset:64 sc1
    v_exp_f32 v227, v67
    v_add_f32 v228, v228, v226
    v_mfma_f32_32x32x16_bf16 v[80:95], a[104:107], a[72:75], v[80:95]
    ds_read_b64_tr_b16 a[244:245], v29 offset:20480
    ds_read_b64_tr_b16 a[246:247], v29 offset:22528
    v_exp_f32 v224, v68
    v_add_f32 v228, v228, v227
    v_cvt_pk_bf16_f32 v145, v226, v227
    v_mfma_f32_32x32x16_bf16 v[80:95], a[108:111], a[76:79], v[80:95]
    ds_read_b64_tr_b16 a[248:249], v30 offset:20480
    buffer_load_dword v62, v244, s[20:23], s17 offen
    v_exp_f32 v225, v69
    v_add_f32 v228, v228, v224
    v_mfma_f32_32x32x16_bf16 v[80:95], a[112:115], a[80:83], v[80:95]
    ds_read_b64_tr_b16 a[250:251], v30 offset:22528
    ds_read_b64_tr_b16 a[252:253], v31 offset:20480
    v_exp_f32 v226, v70
    v_add_f32 v228, v228, v225
    v_cvt_pk_bf16_f32 v146, v224, v225
    s_add_u32 m0, s40, 24576
    v_mfma_f32_32x32x16_bf16 v[80:95], a[116:119], a[84:87], v[80:95]
    ds_read_b64_tr_b16 a[254:255], v31 offset:22528
    buffer_load_dwordx4 v249, s[24:27], s48 offen offset:0 lds
    v_exp_f32 v227, v71
    v_add_f32 v228, v228, v226
    s_waitcnt vmcnt(11)
    v_mfma_f32_32x32x16_bf16 v[80:95], a[120:123], a[88:91], v[80:95]
    ds_read_b64_tr_b16 a[0:1], v26 offset:0
    ds_read_b64_tr_b16 a[2:3], v26 offset:2048
    ds_read_b64_tr_b16 a[4:5], v27 offset:0
    ds_read_b64_tr_b16 a[6:7], v27 offset:2048
    v_exp_f32 v224, v72
    v_add_f32 v228, v228, v227
    v_cvt_pk_bf16_f32 v147, v226, v227
    v_mfma_f32_32x32x16_bf16 v[80:95], a[124:127], a[92:95], v[80:95]
    ds_read_b64_tr_b16 a[8:9], v26 offset:4096
    ds_read_b64_tr_b16 a[10:11], v26 offset:6144
    buffer_load_dwordx4 v250, s[24:27], s48 offen offset:1024 lds
    v_exp_f32 v225, v73
    v_add_f32 v228, v228, v224
    s_waitcnt lgkmcnt(14)
    v_mfma_f32_32x32x16_bf16 v[160:175], a[224:227], v[152:155], v[160:175]
    ds_read_b64_tr_b16 a[12:13], v27 offset:4096
    ds_read_b64_tr_b16 a[14:15], v27 offset:6144
    ds_read_b64_tr_b16 a[64:65], v24 offset:0
    ds_read_b64_tr_b16 a[66:67], v24 offset:2048
    v_exp_f32 v226, v74
    v_add_f32 v228, v228, v225
    v_cvt_pk_bf16_f32 v148, v224, v225
    v_mfma_f32_32x32x16_bf16 v[176:191], a[228:231], v[152:155], v[176:191]
    ds_read_b64_tr_b16 a[68:69], v24 offset:4096
    ds_read_b64_tr_b16 a[70:71], v24 offset:6144
    buffer_load_dwordx4 v251, s[24:27], s48 offen offset:2048 lds
    v_exp_f32 v227, v75
    v_add_f32 v228, v228, v226
    v_mfma_f32_32x32x16_bf16 v[192:207], a[232:235], v[152:155], v[192:207]
    ds_read_b64_tr_b16 a[96:97], v25 offset:0
    ds_read_b64_tr_b16 a[98:99], v25 offset:2048
    ds_read_b64_tr_b16 a[100:101], v25 offset:4096
    ds_read_b64_tr_b16 a[102:103], v25 offset:6144
    v_exp_f32 v224, v76
    v_add_f32 v228, v228, v227
    v_cvt_pk_bf16_f32 v149, v226, v227
    s_waitcnt lgkmcnt(15)
    s_barrier
    v_mfma_f32_32x32x16_bf16 v[208:223], a[236:239], v[152:155], v[208:223]
    ds_read_b64_tr_b16 a[16:17], v30 offset:0
    ds_read_b64_tr_b16 a[18:19], v30 offset:2048
    ds_read_b64_tr_b16 a[20:21], v31 offset:0
    buffer_load_dwordx4 v252, s[24:27], s48 offen offset:3072 lds
    v_exp_f32 v225, v77
    v_add_f32 v228, v228, v224
    v_mfma_f32_32x32x16_bf16 v[160:175], a[240:243], v[156:159], v[160:175]
    ds_read_b64_tr_b16 a[22:23], v31 offset:2048
    ds_read_b64_tr_b16 a[24:25], v30 offset:4096
    ds_read_b64_tr_b16 a[26:27], v30 offset:6144
    ds_read_b64_tr_b16 a[28:29], v31 offset:4096
    v_exp_f32 v226, v78
    v_add_f32 v228, v228, v225
    v_cvt_pk_bf16_f32 v150, v224, v225
    s_add_u32 m0, s40, 28672
    v_mfma_f32_32x32x16_bf16 v[176:191], a[244:247], v[156:159], v[176:191]
    ds_read_b64_tr_b16 a[30:31], v31 offset:6144
    ds_read_b64_tr_b16 a[72:73], v28 offset:0
    ds_read_b64_tr_b16 a[74:75], v28 offset:2048
    buffer_load_dwordx4 v249, s[24:27], s49 offen offset:0 lds
    v_exp_f32 v227, v79
    v_add_f32 v228, v228, v226
    v_mfma_f32_32x32x16_bf16 v[192:207], a[248:251], v[156:159], v[192:207]
    ds_read_b64_tr_b16 a[76:77], v28 offset:4096
    ds_read_b64_tr_b16 a[78:79], v28 offset:6144
    ds_read_b64_tr_b16 a[104:105], v29 offset:0
    ds_read_b64_tr_b16 a[106:107], v29 offset:2048
    v_exp_f32 v224, v80
    v_add_f32 v228, v228, v227
    v_cvt_pk_bf16_f32 v151, v226, v227
    v_mfma_f32_32x32x16_bf16 v[208:223], a[252:255], v[156:159], v[208:223]
    ds_read_b64_tr_b16 a[108:109], v29 offset:4096
    ds_read_b64_tr_b16 a[110:111], v29 offset:6144
    buffer_load_dwordx4 v250, s[24:27], s49 offen offset:1024 lds
    v_cmp_nge_f32 vcc, s44, v228
    v_exp_f32 v225, v81
    s_cbranch_vccnz K_rare_14
K_back_14:
    s_waitcnt lgkmcnt(15)
    v_mfma_f32_32x32x16_bf16 v[192:207], a[0:3], v[128:131], v[192:207]
    v_exp_f32 v226, v82
    v_add_f32 v45, v45, v228
    v_add_f32 v228, v224, v225
    v_cvt_pk_bf16_f32 v152, v224, v225
    v_exp_f32 v227, v83
    v_add_f32 v228, v228, v226
    s_waitcnt lgkmcnt(0)
    s_waitcnt vmcnt(8)
    s_barrier
    v_mfma_f32_32x32x16_bf16 v[208:223], a[4:7], v[128:131], v[208:223]
    ds_read_b64_tr_b16 a[32:33], v26 offset:8192
    ds_read_b64_tr_b16 a[34:35], v26 offset:10240
    ds_read_b64_tr_b16 a[36:37], v26 offset:12288
    v_exp_f32 v224, v84
    v_add_f32 v228, v228, v227
    v_cvt_pk_bf16_f32 v153, v226, v227
    v_exp_f32 v225, v85
    v_add_f32 v228, v228, v224
    v_mfma_f32_32x32x16_bf16 v[192:207], a[8:11], v[132:135], v[192:207]
    ds_read_b64_tr_b16 a[38:39], v26 offset:14336
    ds_read_b64_tr_b16 a[40:41], v30 offset:8192
    ds_read_b64_tr_b16 a[42:43], v30 offset:10240
    v_exp_f32 v226, v86
    v_add_f32 v228, v228, v225
    v_cvt_pk_bf16_f32 v154, v224, v225
    v_exp_f32 v227, v87
    v_add_f32 v228, v228, v226
    v_mfma_f32_32x32x16_bf16 v[208:223], a[12:15], v[132:135], v[208:223]
    ds_read_b64_tr_b16 a[44:45], v30 offset:12288
    ds_read_b64_tr_b16 a[46:47], v30 offset:14336
    buffer_load_dwordx4 v251, s[24:27], s49 offen offset:2048 lds
    v_exp_f32 v224, v88
    v_add_f32 v228, v228, v227
    v_cvt_pk_bf16_f32 v155, v226, v227
    v_exp_f32 v225, v89
    v_add_f32 v228, v228, v224
    v_mfma_f32_32x32x16_bf16 v[192:207], a[16:19], v[136:139], v[192:207]
    ds_read_b64_tr_b16 a[48:49], v27 offset:8192
    ds_read_b64_tr_b16 a[50:51], v27 offset:10240
    ds_read_b64_tr_b16 a[52:53], v27 offset:12288
    v_exp_f32 v226, v90
    v_add_f32 v228, v228, v225
    v_cvt_pk_bf16_f32 v156, v224, v225
    v_exp_f32 v227, v91
    v_add_f32 v228, v228, v226
    v_mfma_f32_32x32x16_bf16 v[208:223], a[20:23], v[136:139], v[208:223]
    ds_read_b64_tr_b16 a[54:55], v27 offset:14336
    ds_read_b64_tr_b16 a[56:57], v31 offset:8192
    ds_read_b64_tr_b16 a[58:59], v31 offset:10240
    buffer_load_dwordx4 v252, s[24:27], s49 offen offset:3072 lds
    v_exp_f32 v224, v92
    v_add_f32 v228, v228, v227
    v_cvt_pk_bf16_f32 v157, v226, v227
    v_exp_f32 v225, v93
    v_add_f32 v228, v228, v224
    v_mfma_f32_32x32x16_bf16 v[192:207], a[24:27], v[140:143], v[192:207]
    ds_read_b64_tr_b16 a[60:61], v31 offset:12288
    ds_read_b64_tr_b16 a[62:63], v31 offset:14336
    v_exp_f32 v226, v94
    v_add_f32 v228, v228, v225
    v_cvt_pk_bf16_f32 v158, v224, v225
    v_exp_f32 v227, v95
    v_add_f32 v228, v228, v226
    v_mfma_f32_32x32x16_bf16 v[208:223], a[28:31], v[140:143], v[208:223]
    ds_read_b64_tr_b16 a[80:81], v24 offset:8192
    ds_read_b64_tr_b16 a[82:83], v24 offset:10240
    ds_read_b64_tr_b16 a[84:85], v24 offset:12288
    v_add_f32 v228, v228, v227
    v_cvt_pk_bf16_f32 v159, v226, v227
    v_cmp_nge_f32 vcc, s44, v228
    s_cbranch_vccnz K_rare_15
K_back_15:
    v_add_f32 v45, v45, v228
    s_waitcnt lgkmcnt(11)
    v_mfma_f32_32x32x16_bf16 v[192:207], a[32:35], v[144:147], v[192:207]
    ds_read_b64_tr_b16 a[86:87], v24 offset:14336
    ds_read_b64_tr_b16 a[88:89], v28 offset:8192
    ds_read_b64_tr_b16 a[90:91], v28 offset:10240
    v_mov_b32 v48, v45
    v_mov_b32 v49, v45
    v_mov_b32 v112, v96
    s_nop 0
    v_permlane32_swap_b32 v48, v49
    s_nop 1
    v_add_f32 v113, v48, v49
    v_mfma_f32_32x32x16_bf16 v[192:207], a[36:39], v[148:151], v[192:207]
    ds_write_b64 v247, v[112:113] offset:0
    ds_read_b64_tr_b16 a[92:93], v28 offset:12288
    ds_read_b64_tr_b16 a[94:95], v28 offset:14336
    v_mfma_f32_32x32x16_bf16 v[192:207], a[40:43], v[152:155], v[192:207]
    ds_read_b64_tr_b16 a[112:113], v25 offset:8192
    ds_read_b64_tr_b16 a[114:115], v25 offset:10240
    ds_read_b64_tr_b16 a[116:117], v25 offset:12288
    v_mfma_f32_32x32x16_bf16 v[192:207], a[44:47], v[156:159], v[192:207]
    ds_read_b64_tr_b16 a[118:119], v25 offset:14336
    ds_read_b64_tr_b16 a[120:121], v29 offset:8192
    ds_read_b64_tr_b16 a[122:123], v29 offset:10240
    s_waitcnt lgkmcnt(15)
    s_add_u32 m0, s40, 32768
    v_mfma_f32_32x32x16_bf16 v[208:223], a[48:51], v[144:147], v[208:223]
    ds_read_b64_tr_b16 a[124:125], v29 offset:12288
    ds_read_b64_tr_b16 a[126:127], v29 offset:14336
    buffer_load_dwordx4 v249, s[24:27], s50 offen offset:0 lds
    s_waitcnt lgkmcnt(10)
    s_barrier
    v_mfma_f32_32x32x16_bf16 v[208:223], a[52:55], v[148:151], v[208:223]
    ds_read_b64 v[114:115], v248 offset:0
    v_mfma_f32_32x32x16_bf16 v[208:223], a[56:59], v[152:155], v[208:223]
    buffer_load_dwordx4 v250, s[24:27], s50 offen offset:1024 lds
    v_mfma_f32_32x32x16_bf16 v[208:223], a[60:63], v[156:159], v[208:223]
    ds_write_b128 v247, v[192:195] offset:16384
    v_mfma_f32_32x32x16_bf16 v[160:175], a[64:67], v[128:131], v[160:175]
    ds_write_b128 v247, v[196:199] offset:17408
    buffer_load_dwordx4 v251, s[24:27], s50 offen offset:2048 lds
    s_waitcnt lgkmcnt(2)
    v_min_f32 v48, v112, v114
    v_sub_f32 v116, v48, v112
    v_sub_f32 v118, v48, v114
    v_exp_f32 v116, v116
    v_exp_f32 v118, v118
    v_mfma_f32_32x32x16_bf16 v[160:175], a[68:71], v[132:135], v[160:175]
    v_mul_f32 v49, v116, v113
    v_fmac_f32 v49, v118, v115
    v_rcp_f32 v49, v49
    s_nop 0
    v_mfma_f32_32x32x16_bf16 v[160:175], a[72:75], v[136:139], v[160:175]
    ds_write_b128 v247, v[200:203] offset:18432
    buffer_load_dwordx4 v252, s[24:27], s50 offen offset:3072 lds
    v_mul_f32 v116, v116, v49
    v_mul_f32 v118, v118, v49
    v_mfma_f32_32x32x16_bf16 v[160:175], a[76:79], v[140:143], v[160:175]
    ds_write_b128 v247, v[204:207] offset:19456
    s_add_u32 m0, s40, 36864
    v_mfma_f32_32x32x16_bf16 v[160:175], a[80:83], v[144:147], v[160:175]
    buffer_load_dwordx4 v249, s[24:27], s51 offen offset:0 lds
    v_mfma_f32_32x32x16_bf16 v[160:175], a[84:87], v[148:151], v[160:175]
    ds_write_b128 v247, v[208:211] offset:20480
    v_mfma_f32_32x32x16_bf16 v[160:175], a[88:91], v[152:155], v[160:175]
    ds_write_b128 v247, v[212:215] offset:21504
    buffer_load_dwordx4 v250, s[24:27], s51 offen offset:1024 lds
    v_mfma_f32_32x32x16_bf16 v[160:175], a[92:95], v[156:159], v[160:175]
    v_mfma_f32_32x32x16_bf16 v[176:191], a[96:99], v[128:131], v[176:191]
    ds_write_b128 v247, v[216:219] offset:22528
    buffer_load_dwordx4 v251, s[24:27], s51 offen offset:2048 lds
    v_mfma_f32_32x32x16_bf16 v[176:191], a[100:103], v[132:135], v[176:191]
    ds_write_b128 v247, v[220:223] offset:23552
    s_nop 3
    v_mfma_f32_32x32x16_bf16 v[176:191], a[104:107], v[136:139], v[176:191]
    buffer_load_dwordx4 v252, s[24:27], s51 offen offset:3072 lds
    s_nop 3
    s_waitcnt lgkmcnt(0)
    s_barrier
    v_mfma_f32_32x32x16_bf16 v[176:191], a[108:111], v[140:143], v[176:191]
    ds_read_b128 v[64:67], v248 offset:16384
    ds_read_b128 v[68:71], v248 offset:17408
    ds_read_b128 v[72:75], v248 offset:18432
    ds_read_b128 v[76:79], v248 offset:19456
    v_mul_f32 v160, v116, v160
    v_mul_f32 v161, v116, v161
    v_mul_f32 v162, v116, v162
    v_mul_f32 v163, v116, v163
    s_add_u32 m0, s40, 8192
    v_mfma_f32_32x32x16_bf16 v[176:191], a[112:115], v[144:147], v[176:191]
    buffer_load_dwordx4 v249, s[24:27], s52 offen offset:0 lds
    ds_read_b128 v[80:83], v248 offset:20480
    ds_read_b128 v[84:87], v248 offset:21504
    ds_read_b128 v[88:91], v248 offset:22528
    ds_read_b128 v[92:95], v248 offset:23552
    v_mul_f32 v164, v116, v164
    v_mul_f32 v165, v116, v165
    v_mul_f32 v166, v116, v166
    v_mul_f32 v167, v116, v167
    v_mfma_f32_32x32x16_bf16 v[176:191], a[116:119], v[148:151], v[176:191]
    buffer_load_dwordx4 v250, s[24:27], s52 offen offset:1024 lds
    v_mul_f32 v168, v116, v168
    v_mul_f32 v169, v116, v169
    v_mul_f32 v170, v116, v170
    v_mul_f32 v171, v116, v171
    v_mfma_f32_32x32x16_bf16 v[176:191], a[120:123], v[152:155], v[176:191]
    buffer_load_dwordx4 v251, s[24:27], s52 offen offset:2048 lds
    v_mul_f32 v172, v116, v172
    v_mul_f32 v173, v116, v173
    v_mul_f32 v174, v116, v174
    v_mul_f32 v175, v116, v175
    v_mfma_f32_32x32x16_bf16 v[176:191], a[124:127], v[156:159], v[176:191]
    buffer_load_dwordx4 v252, s[24:27], s52 offen offset:3072 lds
    s_waitcnt lgkmcnt(4)
    v_pk_fma_f32 v[160:161], v[118:119], v[64:65], v[160:161] op_sel_hi:[0,1,1]
    v_pk_fma_f32 v[162:163], v[118:119], v[66:67], v[162:163] op_sel_hi:[0,1,1]
    v_pk_fma_f32 v[164:165], v[118:119], v[68:69], v[164:165] op_sel_hi:[0,1,1]
    v_pk_fma_f32 v[166:167], v[118:119], v[70:71], v[166:167] op_sel_hi:[0,1,1]
    v_pk_fma_f32 v[168:169], v[118:119], v[72:73], v[168:169] op_sel_hi:[0,1,1]
    v_pk_fma_f32 v[170:171], v[118:119], v[74:75], v[170:171] op_sel_hi:[0,1,1]
    v_pk_fma_f32 v[172:173], v[118:119], v[76:77], v[172:173] op_sel_hi:[0,1,1]
    v_pk_fma_f32 v[174:175], v[118:119], v[78:79], v[174:175] op_sel_hi:[0,1,1]
    v_cvt_pk_bf16_f32 v96, v160, v161
    v_cvt_pk_bf16_f32 v97, v162, v163
    v_cvt_pk_bf16_f32 v98, v164, v165
    v_cvt_pk_bf16_f32 v99, v166, v167
    v_cvt_pk_bf16_f32 v100, v168, v169
    v_cvt_pk_bf16_f32 v101, v170, v171
    v_cvt_pk_bf16_f32 v102, v172, v173
    v_cvt_pk_bf16_f32 v103, v174, v175
    buffer_store_dwordx4 v[96:99], v47, s[20:23], s4 offen offset:0 sc1
    buffer_store_dwordx4 v[100:103], v47, s[20:23], s4 offen offset:1024 sc1
    s_waitcnt lgkmcnt(0)
    v_pk_mul_f32 v[80:81], v[118:119], v[80:81] op_sel_hi:[0,1]
    v_pk_mul_f32 v[82:83], v[118:119], v[82:83] op_sel_hi:[0,1]
    v_pk_mul_f32 v[84:85], v[118:119], v[84:85] op_sel_hi:[0,1]
    v_pk_mul_f32 v[86:87], v[118:119], v[86:87] op_sel_hi:[0,1]
    v_pk_mul_f32 v[88:89], v[118:119], v[88:89] op_sel_hi:[0,1]
    v_pk_mul_f32 v[90:91], v[118:119], v[90:91] op_sel_hi:[0,1]
    v_pk_mul_f32 v[92:93], v[118:119], v[92:93] op_sel_hi:[0,1]
    v_pk_mul_f32 v[94:95], v[118:119], v[94:95] op_sel_hi:[0,1]
    v_pk_fma_f32 v[176:177], v[116:117], v[176:177], v[80:81] op_sel_hi:[0,1,1]
    v_pk_fma_f32 v[178:179], v[116:117], v[178:179], v[82:83] op_sel_hi:[0,1,1]
    v_pk_fma_f32 v[180:181], v[116:117], v[180:181], v[84:85] op_sel_hi:[0,1,1]
    v_pk_fma_f32 v[182:183], v[116:117], v[182:183], v[86:87] op_sel_hi:[0,1,1]
    v_pk_fma_f32 v[184:185], v[116:117], v[184:185], v[88:89] op_sel_hi:[0,1,1]
    v_pk_fma_f32 v[186:187], v[116:117], v[186:187], v[90:91] op_sel_hi:[0,1,1]
    v_pk_fma_f32 v[188:189], v[116:117], v[188:189], v[92:93] op_sel_hi:[0,1,1]
    v_pk_fma_f32 v[190:191], v[116:117], v[190:191], v[94:95] op_sel_hi:[0,1,1]
    v_cvt_pk_bf16_f32 v104, v176, v177
    v_cvt_pk_bf16_f32 v105, v178, v179
    v_cvt_pk_bf16_f32 v106, v180, v181
    v_cvt_pk_bf16_f32 v107, v182, v183
    v_cvt_pk_bf16_f32 v108, v184, v185
    v_cvt_pk_bf16_f32 v109, v186, v187
    v_cvt_pk_bf16_f32 v110, v188, v189
    v_cvt_pk_bf16_f32 v111, v190, v191
    buffer_store_dwordx4 v[104:107], v47, s[20:23], s4 offen offset:2048 sc1
    buffer_store_dwordx4 v[108:111], v47, s[20:23], s4 offen offset:3072 sc1
    ds_write_b128 v247, v[96:99] offset:4096
    ds_write_b128 v247, v[100:103] offset:5120
    ds_write_b128 v247, v[104:107] offset:6144
    ds_write_b128 v247, v[108:111] offset:7168
    s_waitcnt vmcnt(16)
    ds_read_b64_tr_b16 a[128:129], v253 offset:24576
    ds_read_b64_tr_b16 a[130:131], v253 offset:25088
    ds_read_b64_tr_b16 a[132:133], v253 offset:25600
    ds_read_b64_tr_b16 a[134:135], v253 offset:26112
    ds_read_b64_tr_b16 a[136:137], v253 offset:26624
    ds_read_b64_tr_b16 a[138:139], v253 offset:27136
    ds_read_b64_tr_b16 a[140:141], v253 offset:27648
    ds_read_b64_tr_b16 a[142:143], v253 offset:28160
    ds_read_b64_tr_b16 a[144:145], v253 offset:28672
    ds_read_b64_tr_b16 a[146:147], v253 offset:29184
    ds_read_b64_tr_b16 a[148:149], v253 offset:29696
    ds_read_b64_tr_b16 a[150:151], v253 offset:30208
    ds_read_b64_tr_b16 a[152:153], v253 offset:30720
    ds_read_b64_tr_b16 a[154:155], v253 offset:31232
    ds_read_b64_tr_b16 a[156:157], v253 offset:31744
    ds_read_b64_tr_b16 a[158:159], v253 offset:32256
    v_cmp_ne_u64 vcc, v[60:61], v[232:233]
    s_nop 1
    s_cmp_eq_u64 vcc, 0
    s_cselect_b32 s41, 1, 0
    s_waitcnt lgkmcnt(15)
    s_barrier
    ds_read_b128 a[0:3], v41 offset:4096
    ds_read_b128 a[4:7], v42 offset:4096
    ds_read_b128 a[8:11], v41 offset:5120
    ds_read_b128 a[12:15], v42 offset:5120
    ds_read_b128 a[16:19], v41 offset:6144
    ds_read_b128 a[20:23], v42 offset:6144
    ds_read_b128 a[24:27], v41 offset:7168
    ds_read_b128 a[28:31], v42 offset:7168
    ds_read_b128 a[32:35], v43 offset:4096
    ds_read_b128 a[36:39], v44 offset:4096
    ds_read_b128 a[40:43], v43 offset:5120
    ds_read_b128 a[44:47], v44 offset:5120
    ds_read_b128 a[48:51], v43 offset:6144
    ds_read_b128 a[52:55], v44 offset:6144
    ds_read_b128 a[56:59], v43 offset:7168
    ds_read_b128 a[60:63], v44 offset:7168
    s_mov_b32 s101, 200000
    s_xor_b32 s98, s4, 131072
    s_xor_b32 s99, s4, 262144
    s_xor_b32 s100, s4, 393216
    s_add_u32 s97, s7, 0x10000
    s_mov_b32 s44, 0xffff
    s_waitcnt lgkmcnt(12)
    s_add_u32 m0, s40, 12288
    v_mfma_f32_32x32x16_bf16 v[64:79], a[128:131], a[0:3], 0
    buffer_load_dwordx4 v249, s[24:27], s53 offen offset:0 lds
    v_mfma_f32_32x32x16_bf16 v[80:95], a[128:131], a[4:7], 0
    buffer_load_dwordx4 v250, s[24:27], s53 offen offset:1024 lds
    s_cmp_eq_u32 s41, 1
    s_waitcnt vmcnt(2)
    s_mov_b64 exec, 1
    s_cbranch_scc0 K_fslow
    buffer_store_dwordx2 v[58:59], v239, s[20:23], s5 offen
K_fback:
    s_mov_b64 exec, -1
    v_mfma_f32_32x32x16_bf16 v[64:79], a[132:135], a[8:11], v[64:79]
    buffer_load_dwordx4 v251, s[24:27], s53 offen offset:2048 lds
    v_mfma_f32_32x32x16_bf16 v[80:95], a[132:135], a[12:15], v[80:95]
    buffer_load_dwordx4 v252, s[24:27], s53 offen offset:3072 lds
    s_waitcnt lgkmcnt(8)
    s_add_u32 m0, s40, 24576
    v_mfma_f32_32x32x16_bf16 v[64:79], a[136:139], a[16:19], v[64:79]
    buffer_load_dwordx4 v249, s[24:27], s54 offen offset:0 lds
    ds_read_b64_tr_b16 a[160:161], v253 offset:32768
    ds_read_b64_tr_b16 a[162:163], v253 offset:33280
    ds_read_b64_tr_b16 a[164:165], v253 offset:33792
    ds_read_b64_tr_b16 a[166:167], v253 offset:34304
    v_mfma_f32_32x32x16_bf16 v[80:95], a[136:139], a[20:23], v[80:95]
    buffer_load_dwordx4 v250, s[24:27], s54 offen offset:1024 lds
    ds_read_b64_tr_b16 a[168:169], v253 offset:34816
    ds_read_b64_tr_b16 a[170:171], v253 offset:35328
    ds_read_b64_tr_b16 a[172:173], v253 offset:35840
    ds_read_b64_tr_b16 a[174:175], v253 offset:36352
    v_mfma_f32_32x32x16_bf16 v[64:79], a[140:143], a[24:27], v[64:79]
    buffer_load_dwordx4 v251, s[24:27], s54 offen offset:2048 lds
    ds_read_b64_tr_b16 a[176:177], v253 offset:36864
    ds_read_b64_tr_b16 a[178:179], v253 offset:37376
    ds_read_b64_tr_b16 a[180:181], v253 offset:37888
    ds_read_b64_tr_b16 a[182:183], v253 offset:38400
    v_mfma_f32_32x32x16_bf16 v[80:95], a[140:143], a[28:31], v[80:95]
    buffer_load_dwordx4 v252, s[24:27], s54 offen offset:3072 lds
    ds_read_b64_tr_b16 a[184:185], v253 offset:38912
    ds_read_b64_tr_b16 a[186:187], v253 offset:39424
    ds_read_b64_tr_b16 a[188:189], v253 offset:39936
    ds_read_b64_tr_b16 a[190:191], v253 offset:40448
    s_waitcnt lgkmcnt(15)
    s_add_u32 m0, s40, 28672
    v_mfma_f32_32x32x16_bf16 v[64:79], a[144:147], a[32:35], v[64:79]
    buffer_load_dwordx2 v[60:61], v63, s[20:23], s6 offen sc1
    buffer_load_dwordx4 v249, s[24:27], s55 offen offset:0 lds
    v_mfma_f32_32x32x16_bf16 v[80:95], a[144:147], a[36:39], v[80:95]
    buffer_load_dwordx4 v250, s[24:27], s55 offen offset:1024 lds
    v_mfma_f32_32x32x16_bf16 v[64:79], a[148:151], a[40:43], v[64:79]
    buffer_load_dwordx4 v251, s[24:27], s55 offen offset:2048 lds
    s_waitcnt vmcnt(8)
    v_mfma_f32_32x32x16_bf16 v[80:95], a[148:151], a[44:47], v[80:95]
    buffer_load_dwordx4 v252, s[24:27], s55 offen offset:3072 lds
    ds_read_b64_tr_b16 a[192:193], v253 offset:8192
    ds_read_b64_tr_b16 a[194:195], v253 offset:8704
    ds_read_b64_tr_b16 a[196:197], v253 offset:9216
    ds_read_b64_tr_b16 a[198:199], v253 offset:9728
    s_waitcnt lgkmcnt(15)
    v_mfma_f32_32x32x16_bf16 v[64:79], a[152:155], a[48:51], v[64:79]
    ds_read_b64_tr_b16 a[200:201], v253 offset:10240
    ds_read_b64_tr_b16 a[202:203], v253 offset:10752
    ds_read_b64_tr_b16 a[204:205], v253 offset:11264
    ds_read_b64_tr_b16 a[206:207], v253 offset:11776
    v_mfma_f32_32x32x16_bf16 v[80:95], a[152:155], a[52:55], v[80:95]
    ds_read_b64_tr_b16 a[208:209], v253 offset:12288
    ds_read_b64_tr_b16 a[210:211], v253 offset:12800
    ds_read_b64_tr_b16 a[212:213], v253 offset:13312
    ds_read_b64_tr_b16 a[214:215], v253 offset:13824
    v_mfma_f32_32x32x16_bf16 v[64:79], a[156:159], a[56:59], v[64:79]
    ds_read_b64_tr_b16 a[216:217], v253 offset:14336
    ds_read_b64_tr_b16 a[218:219], v253 offset:14848
    ds_read_b64_tr_b16 a[220:221], v253 offset:15360
    ds_read_b64_tr_b16 a[222:223], v253 offset:15872
    v_mfma_f32_32x32x16_bf16 v[80:95], a[156:159], a[60:63], v[80:95]
    s_waitcnt vmcnt(4)
    v_cmp_ne_u64 vcc, v[60:61], v[58:59]
    s_cbranch_vccz K_g3
K_p1:
    buffer_load_dwordx2 v[60:61], v63, s[20:23], s6 offen sc1
    s_waitcnt vmcnt(0)
    v_cmp_ne_u64 vcc, v[60:61], v[58:59]
    s_cbranch_vccz K_g3
    s_sub_u32 s101, s101, 1
    s_cbranch_scc0 K_p1
K_g3:
    s_add_u32 m0, s40, 16384
    s_nop 0
    buffer_load_dwordx4 v47, s[20:23], s98 offen offset:0 sc1 lds
    buffer_load_dwordx4 v47, s[20:23], s98 offen offset:1024 sc1 lds
    buffer_load_dwordx4 v47, s[20:23], s98 offen offset:2048 sc1 lds
    buffer_load_dwordx4 v47, s[20:23], s98 offen offset:3072 sc1 lds
    s_add_u32 m0, s40, 20480
    s_nop 0
    buffer_load_dwordx4 v47, s[20:23], s99 offen offset:0 sc1 lds
    buffer_load_dwordx4 v47, s[20:23], s99 offen offset:1024 sc1 lds
    buffer_load_dwordx4 v47, s[20:23], s99 offen offset:2048 sc1 lds
    buffer_load_dwordx4 v47, s[20:23], s99 offen offset:3072 sc1 lds
    s_waitcnt vmcnt(8)
    ds_read_b64_tr_b16 a[224:225], v253 offset:24576
    ds_read_b64_tr_b16 a[226:227], v253 offset:25088
    ds_read_b64_tr_b16 a[228:229], v253 offset:25600
    ds_read_b64_tr_b16 a[230:231], v253 offset:26112
    ds_read_b64_tr_b16 a[232:233], v253 offset:26624
    ds_read_b64_tr_b16 a[234:235], v253 offset:27136
    ds_read_b64_tr_b16 a[236:237], v253 offset:27648
    ds_read_b64_tr_b16 a[238:239], v253 offset:28160
    ds_read_b64_tr_b16 a[240:241], v253 offset:28672
    ds_read_b64_tr_b16 a[242:243], v253 offset:29184
    ds_read_b64_tr_b16 a[244:245], v253 offset:29696
    ds_read_b64_tr_b16 a[246:247], v253 offset:30208
    ds_read_b64_tr_b16 a[248:249], v253 offset:30720
    ds_read_b64_tr_b16 a[250:251], v253 offset:31232
    ds_read_b64_tr_b16 a[252:253], v253 offset:31744
    ds_read_b64_tr_b16 a[254:255], v253 offset:32256
    s_waitcnt vmcnt(6)
    s_barrier
    ds_read_b128 a[64:67], v41 offset:16384
    ds_read_b128 a[68:71], v42 offset:16384
    ds_read_b128 a[72:75], v41 offset:17408
    ds_read_b128 a[76:79], v42 offset:17408
    ds_read_b128 a[96:99], v43 offset:16384
    ds_read_b128 a[100:103], v44 offset:16384
    ds_read_b128 a[104:107], v43 offset:17408
    ds_read_b128 a[108:111], v44 offset:17408
    s_waitcnt lgkmcnt(4)
    v_mfma_f32_32x32x16_bf16 v[64:79], a[160:163], a[64:67], v[64:79]
    s_add_u32 m0, s40, 32768
    v_mfma_f32_32x32x16_bf16 v[80:95], a[160:163], a[68:71], v[80:95]
    buffer_load_dwordx4 v47, s[20:23], s100 offen offset:0 sc1 lds
    s_waitcnt vmcnt(5)
    s_barrier
    v_mfma_f32_32x32x16_bf16 v[64:79], a[164:167], a[72:75], v[64:79]
    ds_read_b128 a[80:83], v41 offset:18432
    ds_read_b128 a[84:87], v42 offset:18432
    v_mfma_f32_32x32x16_bf16 v[80:95], a[164:167], a[76:79], v[80:95]
    ds_read_b128 a[88:91], v41 offset:19456
    ds_read_b128 a[92:95], v42 offset:19456
    buffer_load_dwordx4 v47, s[20:23], s100 offen offset:1024 sc1 lds
    s_waitcnt lgkmcnt(4)
    v_mfma_f32_32x32x16_bf16 v[64:79], a[176:179], a[96:99], v[64:79]
    ds_read_b128 a[112:115], v43 offset:18432
    ds_read_b128 a[116:119], v44 offset:18432
    v_mfma_f32_32x32x16_bf16 v[80:95], a[176:179], a[100:103], v[80:95]
    ds_read_b128 a[120:123], v43 offset:19456
    ds_read_b128 a[124:127], v44 offset:19456
    buffer_load_dwordx4 v47, s[20:23], s100 offen offset:2048 sc1 lds
    v_mfma_f32_32x32x16_bf16 v[64:79], a[180:183], a[104:107], v[64:79]
    v_mfma_f32_32x32x16_bf16 v[80:95], a[180:183], a[108:111], v[80:95]
    buffer_load_dwordx4 v47, s[20:23], s100 offen offset:3072 sc1 lds
    s_waitcnt lgkmcnt(0)
    v_mfma_f32_32x32x16_bf16 v[64:79], a[168:171], a[80:83], v[64:79]
    s_waitcnt vmcnt(4)
    s_barrier
    v_mfma_f32_32x32x16_bf16 v[80:95], a[168:171], a[84:87], v[80:95]
    ds_read_b128 a[0:3], v41 offset:20480
    ds_read_b128 a[4:7], v42 offset:20480
    v_mfma_f32_32x32x16_bf16 v[64:79], a[172:175], a[88:91], v[64:79]
    ds_read_b128 a[8:11], v41 offset:21504
    ds_read_b128 a[12:15], v42 offset:21504
    v_mfma_f32_32x32x16_bf16 v[80:95], a[172:175], a[92:95], v[80:95]
    ds_read_b128 a[16:19], v41 offset:22528
    ds_read_b128 a[20:23], v42 offset:22528
    v_mfma_f32_32x32x16_bf16 v[64:79], a[184:187], a[112:115], v[64:79]
    ds_read_b128 a[24:27], v41 offset:23552
    ds_read_b128 a[28:31], v42 offset:23552
    v_mfma_f32_32x32x16_bf16 v[80:95], a[184:187], a[116:119], v[80:95]
    ds_read_b128 a[32:35], v43 offset:20480
    ds_read_b128 a[36:39], v44 offset:20480
    v_mfma_f32_32x32x16_bf16 v[64:79], a[188:191], a[120:123], v[64:79]
    ds_read_b128 a[40:43], v43 offset:21504
    ds_read_b128 a[44:47], v44 offset:21504
    v_mfma_f32_32x32x16_bf16 v[80:95], a[188:191], a[124:127], v[80:95]
    ds_read_b128 a[48:51], v43 offset:22528
    ds_read_b128 a[52:55], v44 offset:22528
    s_waitcnt lgkmcnt(6)
    v_mfma_f32_32x32x16_bf16 v[64:79], a[192:195], a[0:3], v[64:79]
    ds_read_b128 a[56:59], v43 offset:23552
    ds_read_b128 a[60:63], v44 offset:23552
    v_mfma_f32_32x32x16_bf16 v[80:95], a[192:195], a[4:7], v[80:95]
    v_mfma_f32_32x32x16_bf16 v[64:79], a[196:199], a[8:11], v[64:79]
    v_mfma_f32_32x32x16_bf16 v[80:95], a[196:199], a[12:15], v[80:95]
    v_mfma_f32_32x32x16_bf16 v[64:79], a[200:203], a[16:19], v[64:79]
    v_mfma_f32_32x32x16_bf16 v[80:95], a[200:203], a[20:23], v[80:95]
    s_waitcnt vmcnt(0)
    s_barrier
    v_mfma_f32_32x32x16_bf16 v[64:79], a[204:207], a[24:27], v[64:79]
    ds_read_b128 a[64:67], v41 offset:32768
    ds_read_b128 a[68:71], v42 offset:32768
    v_mfma_f32_32x32x16_bf16 v[80:95], a[204:207], a[28:31], v[80:95]
    ds_read_b128 a[72:75], v41 offset:33792
    ds_read_b128 a[76:79], v42 offset:33792
    s_waitcnt lgkmcnt(4)
    v_mfma_f32_32x32x16_bf16 v[64:79], a[208:211], a[32:35], v[64:79]
    ds_read_b128 a[80:83], v41 offset:34816
    ds_read_b128 a[84:87], v42 offset:34816
    v_mfma_f32_32x32x16_bf16 v[64:79], a[212:215], a[40:43], v[64:79]
    ds_read_b128 a[88:91], v41 offset:35840
    ds_read_b128 a[92:95], v42 offset:35840
    v_mfma_f32_32x32x16_bf16 v[64:79], a[216:219], a[48:51], v[64:79]
    ds_read_b128 a[96:99], v43 offset:32768
    ds_read_b128 a[100:103], v44 offset:32768
    v_mfma_f32_32x32x16_bf16 v[64:79], a[220:223], a[56:59], v[64:79]
    ds_read_b128 a[104:107], v43 offset:33792
    ds_read_b128 a[108:111], v44 offset:33792
    s_waitcnt lgkmcnt(4)
    v_mfma_f32_32x32x16_bf16 v[64:79], a[224:227], a[64:67], v[64:79]
    ds_read_b128 a[112:115], v43 offset:34816
    ds_read_b128 a[116:119], v44 offset:34816
    v_mfma_f32_32x32x16_bf16 v[80:95], a[224:227], a[68:71], v[80:95]
    ds_read_b128 a[120:123], v43 offset:35840
    ds_read_b128 a[124:127], v44 offset:35840
    v_mfma_f32_32x32x16_bf16 v[64:79], a[228:231], a[72:75], v[64:79]
    s_add_u32 s98, s17, 0x20000
    s_lshl_b32 s99, s37, 9
    s_sub_u32 s99, s98, s99
    v_mfma_f32_32x32x16_bf16 v[80:95], a[228:231], a[76:79], v[80:95]
    v_mfma_f32_32x32x16_bf16 v[64:79], a[232:235], a[80:83], v[64:79]
    v_mfma_f32_32x32x16_bf16 v[80:95], a[232:235], a[84:87], v[80:95]
    v_mfma_f32_32x32x16_bf16 v[64:79], a[236:239], a[88:91], v[64:79]
    v_mfma_f32_32x32x16_bf16 v[80:95], a[236:239], a[92:95], v[80:95]
    s_waitcnt lgkmcnt(0)
    v_mfma_f32_32x32x16_bf16 v[64:79], a[240:243], a[96:99], v[64:79]
    v_mfma_f32_32x32x16_bf16 v[64:79], a[244:247], a[104:107], v[64:79]
    v_mfma_f32_32x32x16_bf16 v[64:79], a[248:251], a[112:115], v[64:79]
    v_mfma_f32_32x32x16_bf16 v[64:79], a[252:255], a[120:123], v[64:79]
K_gjoin:
    v_mfma_f32_32x32x16_bf16 v[80:95], a[208:211], a[36:39], v[80:95]
    s_nop 4
    v_mfma_f32_32x32x16_bf16 v[80:95], a[212:215], a[44:47], v[80:95]
    s_nop 3
    v_mfma_f32_32x32x16_bf16 v[80:95], a[216:219], a[52:55], v[80:95]
    s_mov_b64 exec, 15
    buffer_store_dword v234, v237, s[20:23], s98 offen sc1
    s_mov_b64 exec, -1
    v_cvt_pk_bf16_f32 v96, v64, v65
    v_cvt_pk_bf16_f32 v97, v66, v67
    v_cvt_pk_bf16_f32 v98, v68, v69
    v_cvt_pk_bf16_f32 v99, v70, v71
    v_mfma_f32_32x32x16_bf16 v[80:95], a[220:223], a[60:63], v[80:95]
    buffer_store_dwordx4 v[96:99], v235, s[20:23], s7 offen sc1
    v_cvt_pk_bf16_f32 v100, v72, v73
    v_cvt_pk_bf16_f32 v101, v74, v75
    v_cvt_pk_bf16_f32 v102, v76, v77
    v_cvt_pk_bf16_f32 v103, v78, v79
    v_mfma_f32_32x32x16_bf16 v[80:95], a[240:243], a[100:103], v[80:95]
    buffer_store_dwordx4 v[100:103], v235, s[20:23], s7 offen offset:256 sc1
    v_bitop3_b32 v48, v96, v97, v98 bitop3:0x96
    v_bitop3_b32 v50, v99, v100, v101 bitop3:0x96
    v_bitop3_b32 v48, v48, v102, v103 bitop3:0x96
    v_xor_b32 v48, v48, v50
    v_mfma_f32_32x32x16_bf16 v[80:95], a[244:247], a[108:111], v[80:95]
    v_lshrrev_b32 v50, 16, v48
    v_xor_b32 v48, v48, v50
    v_and_or_b32 v48, v48, s44, v234
    v_mfma_f32_32x32x16_bf16 v[80:95], a[248:251], a[116:119], v[80:95]
    buffer_store_dword v48, v236, s[20:23], s17 offen offset:0 sc1
    v_mfma_f32_32x32x16_bf16 v[80:95], a[252:255], a[124:127], v[80:95]
    v_lshrrev_b32 v52, 2, v1
    v_and_b32 v53, 3, v1
    v_lshlrev_b32 v53, 2, v53
    v_lshl_add_u32 v53, v52, 9, v53
    s_nop 7
    v_cvt_pk_bf16_f32 v104, v80, v81
    v_cvt_pk_bf16_f32 v105, v82, v83
    v_cvt_pk_bf16_f32 v106, v84, v85
    v_cvt_pk_bf16_f32 v107, v86, v87
    buffer_store_dwordx4 v[104:107], v235, s[20:23], s97 offen sc1
    v_cvt_pk_bf16_f32 v108, v88, v89
    v_cvt_pk_bf16_f32 v109, v90, v91
    v_cvt_pk_bf16_f32 v110, v92, v93
    v_cvt_pk_bf16_f32 v111, v94, v95
    buffer_store_dwordx4 v[108:111], v235, s[20:23], s97 offen offset:256 sc1
    v_bitop3_b32 v49, v104, v105, v106 bitop3:0x96
    v_bitop3_b32 v50, v107, v108, v109 bitop3:0x96
    v_bitop3_b32 v49, v49, v110, v111 bitop3:0x96
    v_xor_b32 v49, v49, v50
    v_lshrrev_b32 v50, 16, v49
    v_xor_b32 v49, v49, v50
    v_and_or_b32 v49, v49, s44, v234
    buffer_store_dword v49, v236, s[20:23], s17 offen offset:256 sc1
    s_mov_b32 s101, 200000
    s_mov_b32 exec_hi, 0
K_p2:
    v_mov_b32 v112, 0
    buffer_atomic_or v112, v53, s[20:23], s99 offen sc0 sc1
    s_sub_u32 s101, s101, 1
    s_cbranch_scc1 K_p2done
    s_waitcnt vmcnt(0)
    v_xor_b32 v52, v112, v234
    v_cmp_lt_u32 vcc, 0xffff, v52
    s_and_b64 exec, exec, vcc
    s_cbranch_scc1 K_p2
K_p2done:
    s_mov_b64 exec, -1
    s_mov_b32 s101, 200000
K_g:
    buffer_load_dwordx4 v[116:119], v47, s[20:23], s16 offen offset:0 sc1
    buffer_load_dwordx4 v[120:123], v47, s[20:23], s16 offen offset:1024 sc1
    buffer_load_dwordx4 v[124:127], v47, s[20:23], s16 offen offset:2048 sc1
    buffer_load_dwordx4 v[128:131], v47, s[20:23], s16 offen offset:3072 sc1
    buffer_load_dword v112, v237, s[20:23], s18 offen offset:0 sc1
    buffer_load_dword v113, v237, s[20:23], s18 offen offset:1024 sc1
    buffer_load_dword v114, v237, s[20:23], s18 offen offset:2048 sc1
    buffer_load_dword v115, v237, s[20:23], s18 offen offset:3072 sc1
    s_waitcnt vmcnt(7)
    v_mfma_f32_32x32x16_bf16 v[144:159], v[240:243], v[116:119], 0
    v_bitop3_b32 v54, v116, v117, v118 bitop3:0x96
    v_xor_b32 v54, v54, v119
    s_waitcnt vmcnt(6)
    v_mfma_f32_32x32x16_bf16 v[144:159], v[240:243], v[120:123], v[144:159]
    v_bitop3_b32 v54, v54, v120, v121 bitop3:0x96
    v_bitop3_b32 v54, v54, v122, v123 bitop3:0x96
    s_waitcnt vmcnt(5)
    v_mfma_f32_32x32x16_bf16 v[144:159], v[240:243], v[124:127], v[144:159]
    v_bitop3_b32 v54, v54, v124, v125 bitop3:0x96
    v_bitop3_b32 v54, v54, v126, v127 bitop3:0x96
    s_waitcnt vmcnt(4)
    v_mfma_f32_32x32x16_bf16 v[144:159], v[240:243], v[128:131], v[144:159]
    v_bitop3_b32 v54, v54, v128, v129 bitop3:0x96
    v_bitop3_b32 v54, v54, v130, v131 bitop3:0x96
    v_mov_b32 v55, v54
    s_nop 1
    v_permlane16_swap_b32 v54, v55
    s_nop 1
    v_xor_b32 v54, v54, v55
    v_lshrrev_b32 v55, 16, v54
    s_waitcnt vmcnt(0)
    v_xor_b32 v53, v112, v234
    v_bitop3_b32 v53, v53, v113, v234 bitop3:0xf6
    v_bitop3_b32 v53, v53, v114, v234 bitop3:0xf6
    v_bitop3_b32 v53, v53, v115, v234 bitop3:0xf6
    v_and_b32 v53, 0xffff0000, v53
    v_bitop3_b32 v52, v112, v113, v114 bitop3:0x96
    v_xor_b32 v52, v52, v115
    v_bitop3_b32 v54, v54, v55, v52 bitop3:0x96
    v_and_b32 v54, 0xffff, v54
    v_or_b32 v54, v54, v53
    v_cmp_ne_u32 vcc, 0, v54
    s_cbranch_vccz K_gdone
    s_sub_u32 s101, s101, 1
    s_cbranch_scc0 K_g
K_gdone:
    v_cvt_pk_bf16_f32 v48, v144, v145
    v_cvt_pk_bf16_f32 v49, v146, v147
    buffer_store_dwordx2 v[48:49], v238, s[28:31], s19 offen
K_end:
    s_endpgm
K_fslow:
    buffer_store_dwordx2 v[58:59], v239, s[20:23], s5 offen sc1
    s_branch K_fback
K_hot_end:
K_noncewait:
    s_mov_b32 s101, 200000
K_noncelp:
    buffer_load_dwordx2 v[58:59], v239, s[32:35], 0 offen sc1
    s_waitcnt vmcnt(0)
    v_cmp_eq_u32 vcc, 0, v58
    s_cbranch_vccz K_nonceok
    s_sub_u32 s101, s101, 1
    s_cbranch_scc0 K_noncelp
    s_branch K_nonceok
K_rare_1:
    s_call_b64 s[46:47], K_rb_1
    s_branch K_back_1
K_rare_2:
    s_call_b64 s[46:47], K_rb_2
    s_branch K_back_2
K_rare_3:
    s_call_b64 s[46:47], K_rb_3
    s_branch K_back_3
K_rare_4:
    s_call_b64 s[46:47], K_rb_0
    s_branch K_back_4
K_rare_5:
    s_call_b64 s[46:47], K_rb_1
    s_branch K_back_5
K_rare_6:
    s_call_b64 s[46:47], K_rb_2
    s_branch K_back_6
K_rare_7:
    s_call_b64 s[46:47], K_rb_3
    s_branch K_back_7
K_rare_8:
    s_call_b64 s[46:47], K_rb_0
    s_branch K_back_8
K_rare_9:
    s_call_b64 s[46:47], K_rb_1
    s_branch K_back_9
K_rare_10:
    s_call_b64 s[46:47], K_rb_2
    s_branch K_back_10
K_rare_11:
    s_call_b64 s[46:47], K_rb_3
    s_branch K_back_11
K_rare_12:
    s_call_b64 s[46:47], K_rb_0
    s_branch K_back_12
K_rare_13:
    s_call_b64 s[46:47], K_rb_1
    s_branch K_back_13
K_rare_14:
    s_call_b64 s[46:47], K_rb_2
    s_branch K_back_14
K_rare_15:
    s_call_b64 s[46:47], K_rb_3
    s_branch K_back_15
K_rb_0:
    s_nop 15
    v_max3_f32 v46, v64, v65, v66
    v_max3_f32 v46, v46, v67, v68
    v_max3_f32 v46, v46, v69, v70
    v_max3_f32 v46, v46, v71, v72
    v_max3_f32 v46, v46, v73, v74
    v_max3_f32 v46, v46, v75, v76
    v_max3_f32 v46, v46, v77, v78
    v_max_f32 v46, v46, v79
    s_call_b64 s[98:99], K_rb_common
    v_exp_f32 v224, v64
    v_exp_f32 v225, v65
    v_exp_f32 v226, v66
    v_add_f32 v228, v224, v225
    v_cvt_pk_bf16_f32 v128, v224, v225
    v_exp_f32 v227, v67
    v_add_f32 v228, v228, v226
    v_exp_f32 v224, v68
    v_add_f32 v228, v228, v227
    v_cvt_pk_bf16_f32 v129, v226, v227
    v_exp_f32 v225, v69
    v_add_f32 v228, v228, v224
    v_exp_f32 v226, v70
    v_add_f32 v228, v228, v225
    v_cvt_pk_bf16_f32 v130, v224, v225
    v_exp_f32 v227, v71
    v_add_f32 v228, v228, v226
    v_exp_f32 v224, v72
    v_add_f32 v228, v228, v227
    v_cvt_pk_bf16_f32 v131, v226, v227
    v_exp_f32 v225, v73
    v_add_f32 v228, v228, v224
    v_exp_f32 v226, v74
    v_add_f32 v228, v228, v225
    v_cvt_pk_bf16_f32 v132, v224, v225
    v_exp_f32 v227, v75
    v_add_f32 v228, v228, v226
    v_exp_f32 v224, v76
    v_add_f32 v228, v228, v227
    v_cvt_pk_bf16_f32 v133, v226, v227
    v_exp_f32 v225, v77
    v_add_f32 v228, v228, v224
    v_exp_f32 v226, v78
    v_add_f32 v228, v228, v225
    v_cvt_pk_bf16_f32 v134, v224, v225
    v_exp_f32 v227, v79
    v_add_f32 v228, v228, v226
    v_add_f32 v228, v228, v227
    v_cvt_pk_bf16_f32 v135, v226, v227
    v_exp_f32 v224, v80
    v_exp_f32 v225, v81
    s_nop 3
    s_setpc_b64 s[46:47]
K_rb_1:
    s_nop 15
    v_max3_f32 v46, v80, v81, v82
    v_max3_f32 v46, v46, v83, v84
    v_max3_f32 v46, v46, v85, v86
    v_max3_f32 v46, v46, v87, v88
    v_max3_f32 v46, v46, v89, v90
    v_max3_f32 v46, v46, v91, v92
    v_max3_f32 v46, v46, v93, v94
    v_max_f32 v46, v46, v95
    s_call_b64 s[98:99], K_rb_common
    v_exp_f32 v224, v80
    v_exp_f32 v225, v81
    v_exp_f32 v226, v82
    v_add_f32 v228, v224, v225
    v_cvt_pk_bf16_f32 v136, v224, v225
    v_exp_f32 v227, v83
    v_add_f32 v228, v228, v226
    v_exp_f32 v224, v84
    v_add_f32 v228, v228, v227
    v_cvt_pk_bf16_f32 v137, v226, v227
    v_exp_f32 v225, v85
    v_add_f32 v228, v228, v224
    v_exp_f32 v226, v86
    v_add_f32 v228, v228, v225
    v_cvt_pk_bf16_f32 v138, v224, v225
    v_exp_f32 v227, v87
    v_add_f32 v228, v228, v226
    v_exp_f32 v224, v88
    v_add_f32 v228, v228, v227
    v_cvt_pk_bf16_f32 v139, v226, v227
    v_exp_f32 v225, v89
    v_add_f32 v228, v228, v224
    v_exp_f32 v226, v90
    v_add_f32 v228, v228, v225
    v_cvt_pk_bf16_f32 v140, v224, v225
    v_exp_f32 v227, v91
    v_add_f32 v228, v228, v226
    v_exp_f32 v224, v92
    v_add_f32 v228, v228, v227
    v_cvt_pk_bf16_f32 v141, v226, v227
    v_exp_f32 v225, v93
    v_add_f32 v228, v228, v224
    v_exp_f32 v226, v94
    v_add_f32 v228, v228, v225
    v_cvt_pk_bf16_f32 v142, v224, v225
    v_exp_f32 v227, v95
    v_add_f32 v228, v228, v226
    v_add_f32 v228, v228, v227
    v_cvt_pk_bf16_f32 v143, v226, v227
    v_exp_f32 v224, v64
    v_exp_f32 v225, v65
    s_nop 3
    s_setpc_b64 s[46:47]
K_rb_2:
    s_nop 15
    v_max3_f32 v46, v64, v65, v66
    v_max3_f32 v46, v46, v67, v68
    v_max3_f32 v46, v46, v69, v70
    v_max3_f32 v46, v46, v71, v72
    v_max3_f32 v46, v46, v73, v74
    v_max3_f32 v46, v46, v75, v76
    v_max3_f32 v46, v46, v77, v78
    v_max_f32 v46, v46, v79
    s_call_b64 s[98:99], K_rb_common
    v_exp_f32 v224, v64
    v_exp_f32 v225, v65
    v_exp_f32 v226, v66
    v_add_f32 v228, v224, v225
    v_cvt_pk_bf16_f32 v144, v224, v225
    v_exp_f32 v227, v67
    v_add_f32 v228, v228, v226
    v_exp_f32 v224, v68
    v_add_f32 v228, v228, v227
    v_cvt_pk_bf16_f32 v145, v226, v227
    v_exp_f32 v225, v69
    v_add_f32 v228, v228, v224
    v_exp_f32 v226, v70
    v_add_f32 v228, v228, v225
    v_cvt_pk_bf16_f32 v146, v224, v225
    v_exp_f32 v227, v71
    v_add_f32 v228, v228, v226
    v_exp_f32 v224, v72
    v_add_f32 v228, v228, v227
    v_cvt_pk_bf16_f32 v147, v226, v227
    v_exp_f32 v225, v73
    v_add_f32 v228, v228, v224
    v_exp_f32 v226, v74
    v_add_f32 v228, v228, v225
    v_cvt_pk_bf16_f32 v148, v224, v225
    v_exp_f32 v227, v75
    v_add_f32 v228, v228, v226
    v_exp_f32 v224, v76
    v_add_f32 v228, v228, v227
    v_cvt_pk_bf16_f32 v149, v226, v227
    v_exp_f32 v225, v77
    v_add_f32 v228, v228, v224
    v_exp_f32 v226, v78
    v_add_f32 v228, v228, v225
    v_cvt_pk_bf16_f32 v150, v224, v225
    v_exp_f32 v227, v79
    v_add_f32 v228, v228, v226
    v_add_f32 v228, v228, v227
    v_cvt_pk_bf16_f32 v151, v226, v227
    v_exp_f32 v224, v80
    v_exp_f32 v225, v81
    s_nop 3
    s_setpc_b64 s[46:47]
K_rb_3:
    s_nop 15
    v_max3_f32 v46, v80, v81, v82
    v_max3_f32 v46, v46, v83, v84
    v_max3_f32 v46, v46, v85, v86
    v_max3_f32 v46, v46, v87, v88
    v_max3_f32 v46, v46, v89, v90
    v_max3_f32 v46, v46, v91, v92
    v_max3_f32 v46, v46, v93, v94
    v_max_f32 v46, v46, v95
    s_call_b64 s[98:99], K_rb_common
    v_exp_f32 v224, v80
    v_exp_f32 v225, v81
    v_exp_f32 v226, v82
    v_add_f32 v228, v224, v225
    v_cvt_pk_bf16_f32 v152, v224, v225
    v_exp_f32 v227, v83
    v_add_f32 v228, v228, v226
    v_exp_f32 v224, v84
    v_add_f32 v228, v228, v227
    v_cvt_pk_bf16_f32 v153, v226, v227
    v_exp_f32 v225, v85
    v_add_f32 v228, v228, v224
    v_exp_f32 v226, v86
    v_add_f32 v228, v228, v225
    v_cvt_pk_bf16_f32 v154, v224, v225
    v_exp_f32 v227, v87
    v_add_f32 v228, v228, v226
    v_exp_f32 v224, v88
    v_add_f32 v228, v228, v227
    v_cvt_pk_bf16_f32 v155, v226, v227
    v_exp_f32 v225, v89
    v_add_f32 v228, v228, v224
    v_exp_f32 v226, v90
    v_add_f32 v228, v228, v225
    v_cvt_pk_bf16_f32 v156, v224, v225
    v_exp_f32 v227, v91
    v_add_f32 v228, v228, v226
    v_exp_f32 v224, v92
    v_add_f32 v228, v228, v227
    v_cvt_pk_bf16_f32 v157, v226, v227
    v_exp_f32 v225, v93
    v_add_f32 v228, v228, v224
    v_exp_f32 v226, v94
    v_add_f32 v228, v228, v225
    v_cvt_pk_bf16_f32 v158, v224, v225
    v_exp_f32 v227, v95
    v_add_f32 v228, v228, v226
    v_add_f32 v228, v228, v227
    v_cvt_pk_bf16_f32 v159, v226, v227
    v_exp_f32 v224, v64
    v_exp_f32 v225, v65
    s_nop 3
    s_setpc_b64 s[46:47]
K_rb_common:
    v_mov_b32 v54, v46
    v_mov_b32 v55, v46
    s_nop 1
    v_permlane32_swap_b32 v54, v55
    s_nop 1
    v_max3_f32 v54, v54, v55, 0
    v_ceil_f32 v54, v54
    v_cvt_i32_f32 v55, -v54
    v_ldexp_f32 v55, 1.0, v55
    v_sub_f32 v64, v64, v54
    v_sub_f32 v65, v65, v54
    v_sub_f32 v66, v66, v54
    v_sub_f32 v67, v67, v54
    v_sub_f32 v68, v68, v54
    v_sub_f32 v69, v69, v54
    v_sub_f32 v70, v70, v54
    v_sub_f32 v71, v71, v54
    v_sub_f32 v72, v72, v54
    v_sub_f32 v73, v73, v54
    v_sub_f32 v74, v74, v54
    v_sub_f32 v75, v75, v54
    v_sub_f32 v76, v76, v54
    v_sub_f32 v77, v77, v54
    v_sub_f32 v78, v78, v54
    v_sub_f32 v79, v79, v54
    v_sub_f32 v80, v80, v54
    v_sub_f32 v81, v81, v54
    v_sub_f32 v82, v82, v54
    v_sub_f32 v83, v83, v54
    v_sub_f32 v84, v84, v54
    v_sub_f32 v85, v85, v54
    v_sub_f32 v86, v86, v54
    v_sub_f32 v87, v87, v54
    v_sub_f32 v88, v88, v54
    v_sub_f32 v89, v89, v54
    v_sub_f32 v90, v90, v54
    v_sub_f32 v91, v91, v54
    v_sub_f32 v92, v92, v54
    v_sub_f32 v93, v93, v54
    v_sub_f32 v94, v94, v54
    v_sub_f32 v95, v95, v54
    v_sub_f32 v96, v96, v54
    v_sub_f32 v97, v97, v54
    v_sub_f32 v98, v98, v54
    v_sub_f32 v99, v99, v54
    v_sub_f32 v100, v100, v54
    v_sub_f32 v101, v101, v54
    v_sub_f32 v102, v102, v54
    v_sub_f32 v103, v103, v54
    v_sub_f32 v104, v104, v54
    v_sub_f32 v105, v105, v54
    v_sub_f32 v106, v106, v54
    v_sub_f32 v107, v107, v54
    v_sub_f32 v108, v108, v54
    v_sub_f32 v109, v109, v54
    v_sub_f32 v110, v110, v54
    v_sub_f32 v111, v111, v54
    v_mul_f32 v45, v45, v55
    v_lshlrev_b32 v56, 16, v128
    v_and_b32 v57, 0xffff0000, v128
    v_mul_f32 v56, v56, v55
    v_mul_f32 v57, v57, v55
    v_cvt_pk_bf16_f32 v128, v56, v57
    v_lshlrev_b32 v56, 16, v129
    v_and_b32 v57, 0xffff0000, v129
    v_mul_f32 v56, v56, v55
    v_mul_f32 v57, v57, v55
    v_cvt_pk_bf16_f32 v129, v56, v57
    v_lshlrev_b32 v56, 16, v130
    v_and_b32 v57, 0xffff0000, v130
    v_mul_f32 v56, v56, v55
    v_mul_f32 v57, v57, v55
    v_cvt_pk_bf16_f32 v130, v56, v57
    v_lshlrev_b32 v56, 16, v131
    v_and_b32 v57, 0xffff0000, v131
    v_mul_f32 v56, v56, v55
    v_mul_f32 v57, v57, v55
    v_cvt_pk_bf16_f32 v131, v56, v57
    v_lshlrev_b32 v56, 16, v132
    v_and_b32 v57, 0xffff0000, v132
    v_mul_f32 v56, v56, v55
    v_mul_f32 v57, v57, v55
    v_cvt_pk_bf16_f32 v132, v56, v57
    v_lshlrev_b32 v56, 16, v133
    v_and_b32 v57, 0xffff0000, v133
    v_mul_f32 v56, v56, v55
    v_mul_f32 v57, v57, v55
    v_cvt_pk_bf16_f32 v133, v56, v57
    v_lshlrev_b32 v56, 16, v134
    v_and_b32 v57, 0xffff0000, v134
    v_mul_f32 v56, v56, v55
    v_mul_f32 v57, v57, v55
    v_cvt_pk_bf16_f32 v134, v56, v57
    v_lshlrev_b32 v56, 16, v135
    v_and_b32 v57, 0xffff0000, v135
    v_mul_f32 v56, v56, v55
    v_mul_f32 v57, v57, v55
    v_cvt_pk_bf16_f32 v135, v56, v57
    v_lshlrev_b32 v56, 16, v136
    v_and_b32 v57, 0xffff0000, v136
    v_mul_f32 v56, v56, v55
    v_mul_f32 v57, v57, v55
    v_cvt_pk_bf16_f32 v136, v56, v57
    v_lshlrev_b32 v56, 16, v137
    v_and_b32 v57, 0xffff0000, v137
    v_mul_f32 v56, v56, v55
    v_mul_f32 v57, v57, v55
    v_cvt_pk_bf16_f32 v137, v56, v57
    v_lshlrev_b32 v56, 16, v138
    v_and_b32 v57, 0xffff0000, v138
    v_mul_f32 v56, v56, v55
    v_mul_f32 v57, v57, v55
    v_cvt_pk_bf16_f32 v138, v56, v57
    v_lshlrev_b32 v56, 16, v139
    v_and_b32 v57, 0xffff0000, v139
    v_mul_f32 v56, v56, v55
    v_mul_f32 v57, v57, v55
    v_cvt_pk_bf16_f32 v139, v56, v57
    v_lshlrev_b32 v56, 16, v140
    v_and_b32 v57, 0xffff0000, v140
    v_mul_f32 v56, v56, v55
    v_mul_f32 v57, v57, v55
    v_cvt_pk_bf16_f32 v140, v56, v57
    v_lshlrev_b32 v56, 16, v141
    v_and_b32 v57, 0xffff0000, v141
    v_mul_f32 v56, v56, v55
    v_mul_f32 v57, v57, v55
    v_cvt_pk_bf16_f32 v141, v56, v57
    v_lshlrev_b32 v56, 16, v142
    v_and_b32 v57, 0xffff0000, v142
    v_mul_f32 v56, v56, v55
    v_mul_f32 v57, v57, v55
    v_cvt_pk_bf16_f32 v142, v56, v57
    v_lshlrev_b32 v56, 16, v143
    v_and_b32 v57, 0xffff0000, v143
    v_mul_f32 v56, v56, v55
    v_mul_f32 v57, v57, v55
    v_cvt_pk_bf16_f32 v143, v56, v57
    v_lshlrev_b32 v56, 16, v144
    v_and_b32 v57, 0xffff0000, v144
    v_mul_f32 v56, v56, v55
    v_mul_f32 v57, v57, v55
    v_cvt_pk_bf16_f32 v144, v56, v57
    v_lshlrev_b32 v56, 16, v145
    v_and_b32 v57, 0xffff0000, v145
    v_mul_f32 v56, v56, v55
    v_mul_f32 v57, v57, v55
    v_cvt_pk_bf16_f32 v145, v56, v57
    v_lshlrev_b32 v56, 16, v146
    v_and_b32 v57, 0xffff0000, v146
    v_mul_f32 v56, v56, v55
    v_mul_f32 v57, v57, v55
    v_cvt_pk_bf16_f32 v146, v56, v57
    v_lshlrev_b32 v56, 16, v147
    v_and_b32 v57, 0xffff0000, v147
    v_mul_f32 v56, v56, v55
    v_mul_f32 v57, v57, v55
    v_cvt_pk_bf16_f32 v147, v56, v57
    v_lshlrev_b32 v56, 16, v148
    v_and_b32 v57, 0xffff0000, v148
    v_mul_f32 v56, v56, v55
    v_mul_f32 v57, v57, v55
    v_cvt_pk_bf16_f32 v148, v56, v57
    v_lshlrev_b32 v56, 16, v149
    v_and_b32 v57, 0xffff0000, v149
    v_mul_f32 v56, v56, v55
    v_mul_f32 v57, v57, v55
    v_cvt_pk_bf16_f32 v149, v56, v57
    v_lshlrev_b32 v56, 16, v150
    v_and_b32 v57, 0xffff0000, v150
    v_mul_f32 v56, v56, v55
    v_mul_f32 v57, v57, v55
    v_cvt_pk_bf16_f32 v150, v56, v57
    v_lshlrev_b32 v56, 16, v151
    v_and_b32 v57, 0xffff0000, v151
    v_mul_f32 v56, v56, v55
    v_mul_f32 v57, v57, v55
    v_cvt_pk_bf16_f32 v151, v56, v57
    v_lshlrev_b32 v56, 16, v152
    v_and_b32 v57, 0xffff0000, v152
    v_mul_f32 v56, v56, v55
    v_mul_f32 v57, v57, v55
    v_cvt_pk_bf16_f32 v152, v56, v57
    v_lshlrev_b32 v56, 16, v153
    v_and_b32 v57, 0xffff0000, v153
    v_mul_f32 v56, v56, v55
    v_mul_f32 v57, v57, v55
    v_cvt_pk_bf16_f32 v153, v56, v57
    v_lshlrev_b32 v56, 16, v154
    v_and_b32 v57, 0xffff0000, v154
    v_mul_f32 v56, v56, v55
    v_mul_f32 v57, v57, v55
    v_cvt_pk_bf16_f32 v154, v56, v57
    v_lshlrev_b32 v56, 16, v155
    v_and_b32 v57, 0xffff0000, v155
    v_mul_f32 v56, v56, v55
    v_mul_f32 v57, v57, v55
    v_cvt_pk_bf16_f32 v155, v56, v57
    v_lshlrev_b32 v56, 16, v156
    v_and_b32 v57, 0xffff0000, v156
    v_mul_f32 v56, v56, v55
    v_mul_f32 v57, v57, v55
    v_cvt_pk_bf16_f32 v156, v56, v57
    v_lshlrev_b32 v56, 16, v157
    v_and_b32 v57, 0xffff0000, v157
    v_mul_f32 v56, v56, v55
    v_mul_f32 v57, v57, v55
    v_cvt_pk_bf16_f32 v157, v56, v57
    v_lshlrev_b32 v56, 16, v158
    v_and_b32 v57, 0xffff0000, v158
    v_mul_f32 v56, v56, v55
    v_mul_f32 v57, v57, v55
    v_cvt_pk_bf16_f32 v158, v56, v57
    v_lshlrev_b32 v56, 16, v159
    v_and_b32 v57, 0xffff0000, v159
    v_mul_f32 v56, v56, v55
    v_mul_f32 v57, v57, v55
    v_cvt_pk_bf16_f32 v159, v56, v57
    v_mul_f32 v160, v160, v55
    v_mul_f32 v161, v161, v55
    v_mul_f32 v162, v162, v55
    v_mul_f32 v163, v163, v55
    v_mul_f32 v164, v164, v55
    v_mul_f32 v165, v165, v55
    v_mul_f32 v166, v166, v55
    v_mul_f32 v167, v167, v55
    v_mul_f32 v168, v168, v55
    v_mul_f32 v169, v169, v55
    v_mul_f32 v170, v170, v55
    v_mul_f32 v171, v171, v55
    v_mul_f32 v172, v172, v55
    v_mul_f32 v173, v173, v55
    v_mul_f32 v174, v174, v55
    v_mul_f32 v175, v175, v55
    v_mul_f32 v176, v176, v55
    v_mul_f32 v177, v177, v55
    v_mul_f32 v178, v178, v55
    v_mul_f32 v179, v179, v55
    v_mul_f32 v180, v180, v55
    v_mul_f32 v181, v181, v55
    v_mul_f32 v182, v182, v55
    v_mul_f32 v183, v183, v55
    v_mul_f32 v184, v184, v55
    v_mul_f32 v185, v185, v55
    v_mul_f32 v186, v186, v55
    v_mul_f32 v187, v187, v55
    v_mul_f32 v188, v188, v55
    v_mul_f32 v189, v189, v55
    v_mul_f32 v190, v190, v55
    v_mul_f32 v191, v191, v55
    v_mul_f32 v192, v192, v55
    v_mul_f32 v193, v193, v55
    v_mul_f32 v194, v194, v55
    v_mul_f32 v195, v195, v55
    v_mul_f32 v196, v196, v55
    v_mul_f32 v197, v197, v55
    v_mul_f32 v198, v198, v55
    v_mul_f32 v199, v199, v55
    v_mul_f32 v200, v200, v55
    v_mul_f32 v201, v201, v55
    v_mul_f32 v202, v202, v55
    v_mul_f32 v203, v203, v55
    v_mul_f32 v204, v204, v55
    v_mul_f32 v205, v205, v55
    v_mul_f32 v206, v206, v55
    v_mul_f32 v207, v207, v55
    v_mul_f32 v208, v208, v55
    v_mul_f32 v209, v209, v55
    v_mul_f32 v210, v210, v55
    v_mul_f32 v211, v211, v55
    v_mul_f32 v212, v212, v55
    v_mul_f32 v213, v213, v55
    v_mul_f32 v214, v214, v55
    v_mul_f32 v215, v215, v55
    v_mul_f32 v216, v216, v55
    v_mul_f32 v217, v217, v55
    v_mul_f32 v218, v218, v55
    v_mul_f32 v219, v219, v55
    v_mul_f32 v220, v220, v55
    v_mul_f32 v221, v221, v55
    v_mul_f32 v222, v222, v55
    v_mul_f32 v223, v223, v55
    s_setpc_b64 s[98:99]
    .fill 256, 4, 0xbf810000
.section .rodata,"a"
.p2align 6
.amdhsa_kernel standalone__gqa_block_cached__near_ridge_kernel
  .amdhsa_next_free_vgpr 512
  .amdhsa_next_free_sgpr 102
  .amdhsa_accum_offset 256
  .amdhsa_group_segment_fixed_size 0
  .amdhsa_kernarg_size 64
  .amdhsa_user_sgpr_count 2
  .amdhsa_user_sgpr_kernarg_segment_ptr 1
  .amdhsa_system_sgpr_workgroup_id_x 1
  .amdhsa_float_denorm_mode_32 3
  .amdhsa_float_denorm_mode_16_64 3
.end_amdhsa_kernel
```
